```python
import torch

def _softmax(x, axis=-1):
    return torch.softmax(x, dim=axis)
def _gelu(x):
    return torch.nn.functional.gelu(x, approximate="tanh")
def _silu(x):
    return torch.nn.functional.silu(x)
def _sigmoid(x):
    return torch.sigmoid(x)
def _layernorm(x, axis=-1, eps=1e-5):
    m = x.mean(dim=axis, keepdim=True)
    v = x.var(dim=axis, keepdim=True, unbiased=False)
    return (x - m) / torch.sqrt(v + eps)
def _scatter_add(tgt, idx, src, axis=0):
    return tgt.clone().index_add_(axis, idx, src)
def _segment_sum(src, seg, n):
    out = torch.zeros((n,) + src.shape[1:], dtype=src.dtype)
    return out.index_add_(0, seg, src)
def _pad(x, pw):
    flat = tuple(v for pair in reversed(pw) for v in pair)
    return torch.nn.functional.pad(x, flat)

kernel_name = 'parallel_sum__grouped_kv_mqa__dense_activation_relu__prompt'

def setup_inputs():

    _w = (lambda a: (lambda t: t.to(torch.bfloat16) if t.is_floating_point() else t)(torch.as_tensor(a)))
    def _A_setup():
        B, S, D, H = 1, 2048, 640, 32
        Dh = D // H
        return {
            "x": _w((lambda *s: torch.randn(*s, dtype=torch.bfloat16) * 0.05)(B, S, D)),
            "wq": _w((lambda *s: torch.randn(*s, dtype=torch.bfloat16) * 0.1)(D, H * Dh)),
            "wk": _w((lambda *s: torch.randn(*s, dtype=torch.bfloat16) * 0.1)(D, Dh)),
            "wv": _w((lambda *s: torch.randn(*s, dtype=torch.bfloat16) * 0.05)(D, Dh)),
            "wo": _w((lambda *s: torch.randn(*s, dtype=torch.bfloat16) * 0.05)(H * Dh, D)),
        }
    _A_in = _A_setup()

    def _B_setup():
        B, S, D, Dff = 1, 2048, 640, 1728
        return {
            "x": _w((lambda *s: torch.randn(*s, dtype=torch.bfloat16) * 0.05)(B, S, D)),
            "w1": _w((lambda *s: torch.randn(*s, dtype=torch.bfloat16) * 0.05)(D, Dff)),
            "w2": _w((lambda *s: torch.randn(*s, dtype=torch.bfloat16) * 0.05)(Dff, D)),
        }
    _B_in = _B_setup()

    return {
        "A_x": _A_in["x"],
        "A_wq": _A_in["wq"],
        "A_wk": _A_in["wk"],
        "A_wv": _A_in["wv"],
        "A_wo": _A_in["wo"],
        "B_x": _B_in["x"],
        "B_w1": _B_in["w1"],
        "B_w2": _B_in["w2"],
    }

def reference(A_x, A_wq, A_wk, A_wv, A_wo, B_x, B_w1, B_w2):
    def _A_ref(x, wq, wk, wv, wo):
        B, S, D = x.shape
        H = 32
        Dh = D // H
        q = (lambda x, *d: x.permute(*d))((x @ wq).reshape(B, S, H, Dh), 0, 2, 1, 3)
        k = x @ wk
        v = x @ wv
        scores = torch.einsum("bhqd,bkd->bhqk", q, k) * (Dh ** -0.5)
        p = _softmax(scores, axis=-1)
        o = torch.einsum("bhqk,bkd->bhqd", p, v)
        return (lambda x, *d: x.permute(*d))(o, 0, 2, 1, 3).reshape(B, S, H * Dh) @ wo

    def _B_ref(x, w1, w2):
        h = torch.einsum("bsd,df->bsf", x, w1)
        zero = torch.zeros_like(h)
        h = torch.maximum(h, zero)
        return torch.einsum("bsf,fd->bsd", h, w2)

    x = A_x
    xn = _layernorm(x, axis=-1)
    return x + _A_ref(xn, A_wq, A_wk, A_wv, A_wo) + _B_ref(xn, B_w1, B_w2)
```

```asm
; @launch grid=(256,1,1) block=(512,1,1) lds=157760
.amdgcn_target "amdgcn-amd-amdhsa--gfx950"
.text
.globl parallel_sum__grouped_kv_mqa__dense_activation_relu__prompt_kernel
.p2align 8
.type parallel_sum__grouped_kv_mqa__dense_activation_relu__prompt_kernel,@function
parallel_sum__grouped_kv_mqa__dense_activation_relu__prompt_kernel:
    s_cmp_ge_u32 s2, 256
    s_cbranch_scc1 L_END
    s_load_dwordx16 s[32:47], s[0:1], 0
    s_load_dwordx4 s[48:51], s[0:1], 64
    s_load_dwordx2 s[52:53], s[0:1], 80
    s_memrealtime s[100:101]
    s_getpc_b64 s[4:5]
    s_lshr_b32 s6, s2, 3
    s_and_b32 s6, s6, 15
    s_lshl_b32 s6, s6, 11
    s_add_u32 s4, s4, s6
    s_addc_u32 s5, s5, 0
    v_lshlrev_b32 v60, 2, v0
    v_and_b32 v60, 0x780, v60
    v_mov_b32 v63, s5
    v_add_co_u32 v62, vcc, s4, v60
    s_nop 1
    v_addc_co_u32 v63, vcc, 0, v63, vcc
    global_load_dword v61, v[62:63], off
    v_lshrrev_b32 v4, 6, v0
    v_and_b32 v1, 63, v0
    v_readfirstlane_b32 s24, v4
    s_and_b32 s30, s2, 7
    s_bfe_u32 s3, s2, 0x10003
    s_lshl_b32 s60, s30, 1
    s_add_u32 s26, s60, s3
    s_lshr_b32 s27, s2, 4
    s_sub_u32 s29, s26, 9
    s_cmp_ge_u32 s26, 10
    s_cselect_b32 s60, s29, s26
    s_mov_b32 s98, s60
    s_and_b32 s28, s24, 3
    s_lshl_b32 s29, s26, 2
    s_add_u32 s96, s29, s28
    s_cmp_lt_u32 s24, 4
    s_cbranch_scc1 P1_A
    s_lshl_b32 s29, s96, 5
    v_lshrrev_b32 v4, 3, v1
    v_add_u32 v4, s29, v4
    v_mul_u32_u24 v4, 1280, v4
    v_lshrrev_b32 v5, 4, v1
    v_and_b32 v6, 7, v1
    v_xor_b32 v5, v5, v6
    v_lshl_add_u32 v16, v5, 4, v4
    v_xor_b32 v5, 4, v5
    v_lshl_add_u32 v17, v5, 4, v4
    v_add_u32 v17, 9216, v17
    v_add_u32 v18, 18432, v16
    v_add_u32 v19, 18432, v17
    s_lshl_b32 s55, s60, 7
    s_lshl_b32 s57, s28, 12
    s_add_u32 s57, s57, 20480
    s_waitcnt lgkmcnt(0)
    s_mov_b32 s16, s32
    s_mov_b32 s17, s33
    s_mov_b32 s18, 2621440
    s_mov_b32 s19, 0x00020000
    s_add_u32 m0, s57, 0
    s_nop 0
    buffer_load_dwordx4 v16, s[16:19], s55 offen lds
    buffer_load_dwordx4 v17, s[16:19], s55 offen offset:1024 lds
    buffer_load_dwordx4 v18, s[16:19], s55 offen offset:2048 lds
    buffer_load_dwordx4 v19, s[16:19], s55 offen offset:3072 lds
    s_barrier
    s_cmp_eq_u32 s27, 15
    s_cbranch_scc1 P1_KB
    s_branch P1_GB
P1_A:
    s_cmp_eq_u32 s27, 15
    s_cbranch_scc1 P1_KA0
    s_sub_u32 s29, s27, 4
    s_cmp_lt_u32 s27, 4
    s_mov_b32 s31, 3456
    s_cmov_b32 s31, 1280
    s_cselect_b32 s29, s27, s29
    s_mul_i32 s29, s29, 320
    s_lshl_b32 s95, s28, 4
    s_mul_i32 s95, s95, s31
    s_add_u32 s95, s95, s29
    s_lshl_b32 s54, s31, 6
    s_sub_u32 s31, s31, 320
    v_add_u32 v4, 0, v1
    v_mul_u32_u24 v5, 3277, v4
    v_lshrrev_b32 v5, 16, v5
    v_lshlrev_b32 v4, 4, v1
    v_mad_u32_u24 v56, v5, s31, v4
    v_add_u32 v4, 64, v1
    v_mul_u32_u24 v5, 3277, v4
    v_lshrrev_b32 v5, 16, v5
    v_lshlrev_b32 v4, 4, v1
    v_mad_u32_u24 v57, v5, s31, v4
    v_add_u32 v4, 128, v1
    v_mul_u32_u24 v5, 3277, v4
    v_lshrrev_b32 v5, 16, v5
    v_lshlrev_b32 v4, 4, v1
    v_mad_u32_u24 v58, v5, s31, v4
    v_add_u32 v4, 192, v1
    v_mul_u32_u24 v5, 3277, v4
    v_lshrrev_b32 v5, 16, v5
    v_lshlrev_b32 v4, 4, v1
    v_mad_u32_u24 v59, v5, s31, v4
    v_add_u32 v4, 256, v1
    v_mul_u32_u24 v5, 3277, v4
    v_lshrrev_b32 v5, 16, v5
    v_lshlrev_b32 v4, 4, v4
    v_mad_u32_u24 v60, v5, s31, v4
    s_mul_i32 s90, s60, s54
    s_add_u32 s90, s90, s95
    s_mul_i32 s91, s28, 5120
    s_cmp_lt_u32 s27, 4
    s_waitcnt lgkmcnt(0)
    s_cselect_b32 s8, s34, s44
    s_cselect_b32 s9, s35, s45
    s_mov_b32 s10, 2211840
    s_cmov_b32 s10, 819200
    s_mov_b32 s11, 0x00020000
    s_add_u32 m0, s91, 0
    s_nop 0
    buffer_load_dwordx4 v56, s[8:11], s90 offen lds
    buffer_load_dwordx4 v57, s[8:11], s90 offen offset:1024 lds
    buffer_load_dwordx4 v58, s[8:11], s90 offen offset:2048 lds
    buffer_load_dwordx4 v59, s[8:11], s90 offen offset:3072 lds
    s_add_u32 m0, s91, 4096
    s_nop 0
    buffer_load_dwordx4 v60, s[8:11], s90 offen lds
    s_barrier
    s_mov_b32 s16, s32
    s_mov_b32 s17, s33
    s_mov_b32 s18, 2621440
    s_mov_b32 s19, 0x00020000
    s_lshl_b32 s29, s26, 4
    s_add_u32 s29, s29, s27
    s_lshl_b32 s29, s29, 2
    s_add_u32 s56, s29, s28
    s_mul_i32 s29, s56, 2560
    v_mul_u32_u24 v4, 40, v1
    buffer_load_dwordx4 v[192:195], v4, s[16:19], s29 offen
    buffer_load_dwordx4 v[196:199], v4, s[16:19], s29 offen offset:16
    buffer_load_dwordx2 v[200:201], v4, s[16:19], s29 offen offset:32
    s_mov_b32 s4, s52
    s_mov_b32 s5, s53
    s_mov_b32 s6, 13083648
    s_mov_b32 s7, 0x00020000
    s_mov_b32 s20, s50
    s_mov_b32 s21, s51
    s_mov_b32 s22, 256
    s_mov_b32 s23, 0x00020000
    v_mov_b32 v7, 0
    s_or_b32 s29, s2, s24
    s_cbranch_scc1 NONCE_1
    s_or_b32 s100, s100, 1
    v_mov_b32 v4, s100
    buffer_store_dword v4, v7, s[20:23], 0 offen sc1
NONCE_1:
    v_mov_b64 v[52:53], 0
    v_mov_b64 v[54:55], 0
    v_and_b32 v2, 31, v1
    v_lshrrev_b32 v3, 5, v1
    v_mfma_f32_32x32x8_bf16 v[64:79], v[52:53], v[52:53], 0
    v_mfma_f32_32x32x8_bf16 v[80:95], v[52:53], v[52:53], 0
    v_mfma_f32_32x32x8_bf16 v[96:111], v[52:53], v[52:53], 0
    v_mfma_f32_32x32x8_bf16 v[112:127], v[52:53], v[52:53], 0
    v_mov_b32 v24, 0x3f803f80
    v_mov_b32 v25, 0x3f803f80
    v_bfe_u32 v4, v1, 1, 3
    v_xor_b32 v4, v4, v3
    s_and_b32 s29, s28, 2
    s_lshl_b32 s29, s29, 12
    s_add_u32 s29, s29, 20480
    v_lshl_add_u32 v5, v2, 7, s29
    v_xor_b32 v6, 0, v4
    v_lshl_add_u32 v8, v6, 4, v5
    v_xor_b32 v6, 2, v4
    v_lshl_add_u32 v9, v6, 4, v5
    v_xor_b32 v6, 4, v4
    v_lshl_add_u32 v10, v6, 4, v5
    v_xor_b32 v6, 6, v4
    v_lshl_add_u32 v11, v6, 4, v5
    v_bfe_u32 v4, v1, 2, 2
    v_lshl_add_u32 v22, v3, 3, v4
    v_bfe_u32 v26, v1, 4, 1
    v_and_b32 v27, 3, v1
    v_mul_u32_u24 v22, 320, v22
    s_and_b32 s59, s28, 1
    s_lshl_b32 s59, s59, 1
    s_cmp_lt_u32 s27, 4
    s_cselect_b32 s30, 40, 32
    s_lshl_b32 s29, s30, 1
    s_mul_i32 s29, s29, s59
    v_lshl_add_u32 v16, v27, 3, v22
    v_mad_u32_u24 v16, v26, s30, v16
    v_add_u32 v16, s29, v16
    s_lshl_b32 s30, s30, 1
    v_add_u32 v17, s30, v16
    s_add_u32 s60, s60, 1
    s_cmp_eq_u32 s60, 10
    s_cselect_b32 s60, 0, s60
    s_mul_i32 s90, s60, s54
    s_add_u32 s90, s90, s95
    s_add_u32 s91, s91, 36864
    s_add_u32 m0, s91, 0
    s_nop 0
    buffer_load_dwordx4 v56, s[8:11], s90 offen lds
    buffer_load_dwordx4 v57, s[8:11], s90 offen offset:1024 lds
    buffer_load_dwordx4 v58, s[8:11], s90 offen offset:2048 lds
    buffer_load_dwordx4 v59, s[8:11], s90 offen offset:3072 lds
    s_add_u32 m0, s91, 4096
    s_nop 0
    buffer_load_dwordx4 v60, s[8:11], s90 offen lds
    s_add_u32 s60, s60, 1
    s_cmp_eq_u32 s60, 10
    s_cselect_b32 s60, 0, s60
    s_mul_i32 s90, s60, s54
    s_add_u32 s90, s90, s95
    s_add_u32 s91, s91, 36864
    s_and_b32 s86, s2, 7
    s_lshl_b32 s86, s86, 3
    s_lshr_b32 s29, s2, 5
    s_add_u32 s86, s86, s29
    s_bfe_u32 s87, s2, 0x20003
    s_mul_i32 s92, s86, 153600
    s_mul_i32 s93, s86, 40960
    s_mul_i32 s29, s87, 320
    s_add_u32 s93, s93, s29
    s_lshl_b32 s94, s86, 2
    s_add_u32 s94, s94, s87
    s_lshl_b32 s94, s94, 7
    s_add_u32 s94, s94, 13049856
    s_mul_i32 s61, s96, 153600
    s_mul_i32 s29, s27, 10240
    s_add_u32 s61, s61, s29
    s_cmp_lt_u32 s27, 4
    s_cselect_b32 s63, 0x3ea52b5c, 1.0
    s_lshl_b32 s62, s26, 4
    s_add_u32 s62, s62, s27
    s_lshl_b32 s62, s62, 7
    s_add_u32 s62, s62, 13017088
    s_mov_b32 s97, 0
    s_mov_b32 s58, 0
    s_and_b32 s29, s28, 2
    s_lshl_b32 s30, s29, 10
    s_add_u32 s30, s30, 149504
    v_lshl_add_u32 v20, v2, 5, s30
    s_and_b32 s31, s28, 1
    s_lshl_b32 s30, s31, 10
    s_add_u32 s30, s30, 147456
    v_lshl_add_u32 v23, v1, 3, s30
    s_mul_i32 s30, s31, -149504
    s_add_u32 s61, s61, s30
    v_lshlrev_b32 v6, 4, v1
    s_mov_b32 s16, s46
    s_mov_b32 s17, s47
    s_mov_b32 s18, 2211840
    s_mov_b32 s19, 0x00020000
    s_mul_i32 s51, s26, 15
    s_add_u32 s51, s51, s27
    s_lshl_b32 s51, s51, 2
    s_add_u32 s51, s51, s28
    s_mul_i32 s55, s51, 896
    s_mul_i32 s51, s51, 2304
    s_mov_b32 s12, s40
    s_mov_b32 s13, s41
    s_mov_b32 s14, 819200
    s_mov_b32 s15, 0x00020000
    v_lshlrev_b32 v4, 7, v1
    s_add_u32 m0, s91, 0
    s_nop 0
    buffer_load_dwordx4 v56, s[8:11], s90 offen lds
    buffer_load_dwordx4 v57, s[8:11], s90 offen offset:1024 lds
    s_add_u32 s60, s60, 1
    s_cmp_eq_u32 s60, 10
    s_cselect_b32 s60, 0, s60
    s_mul_i32 s90, s60, s54
    s_add_u32 s90, s90, s95
    s_add_u32 s91, s91, 36864
    s_waitcnt vmcnt(10)
    s_barrier
    ds_read_b128 v[128:131], v8
    ds_read_b64_tr_b16 v[144:145], v16 offset:0
    ds_read_b64_tr_b16 v[146:147], v16 offset:1280
    ds_read_b64_tr_b16 v[148:149], v17 offset:0
    ds_read_b64_tr_b16 v[150:151], v17 offset:1280
    ds_read_b128 v[132:135], v8 offset:4096
    s_mov_b64 vcc, -1
.p2align 3
P1_LGA:
    s_waitcnt lgkmcnt(3)
    v_mfma_f32_32x32x16_bf16 v[64:79], v[144:147], v[128:131], v[64:79]
    ds_read_b128 v[136:139], v9
    ds_read_b64_tr_b16 v[152:153], v16 offset:5120
    ds_read_b64_tr_b16 v[154:155], v16 offset:6400
    s_waitcnt lgkmcnt(3)
    v_mfma_f32_32x32x16_bf16 v[80:95], v[148:151], v[128:131], v[80:95]
    ds_read_b64_tr_b16 v[156:157], v17 offset:5120
    ds_read_b64_tr_b16 v[158:159], v17 offset:6400
    ds_read_b128 v[140:143], v9 offset:4096
    v_mfma_f32_32x32x16_bf16 v[112:127], v[148:151], v[132:135], v[112:127]
    s_cbranch_vccz SK_2
    s_add_u32 m0, s91, 0
    s_nop 0
    buffer_load_dwordx4 v56, s[8:11], s90 offen lds
SK_2:
    v_mfma_f32_32x32x16_bf16 v[96:111], v[144:147], v[132:135], v[96:111]
    s_waitcnt lgkmcnt(3)
    v_mfma_f32_32x32x16_bf16 v[64:79], v[152:155], v[136:139], v[64:79]
    ds_read_b128 v[128:131], v10
    ds_read_b64_tr_b16 v[144:145], v16 offset:10240
    ds_read_b64_tr_b16 v[146:147], v16 offset:11520
    s_waitcnt lgkmcnt(3)
    v_mfma_f32_32x32x16_bf16 v[80:95], v[156:159], v[136:139], v[80:95]
    ds_read_b64_tr_b16 v[148:149], v17 offset:10240
    ds_read_b64_tr_b16 v[150:151], v17 offset:11520
    ds_read_b128 v[132:135], v10 offset:4096
    v_mfma_f32_32x32x16_bf16 v[112:127], v[156:159], v[140:143], v[112:127]
    s_cbranch_vccz SK_3
    buffer_load_dwordx4 v57, s[8:11], s90 offen offset:1024 lds
SK_3:
    v_mfma_f32_32x32x16_bf16 v[96:111], v[152:155], v[140:143], v[96:111]
    s_and_b32 s29, s58, 3
    s_mov_b32 s57, -110592
    s_cmov_b32 s57, 36864
    s_cmp_eq_u32 s29, 3
    s_mov_b32 s59, 36864
    s_cmov_b32 s59, -110592
    s_waitcnt lgkmcnt(3)
    v_mfma_f32_32x32x16_bf16 v[64:79], v[144:147], v[128:131], v[64:79]
    ds_read_b128 v[136:139], v11
    ds_read_b64_tr_b16 v[152:153], v16 offset:15360
    ds_read_b64_tr_b16 v[154:155], v16 offset:16640
    s_waitcnt lgkmcnt(3)
    v_mfma_f32_32x32x16_bf16 v[80:95], v[148:151], v[128:131], v[80:95]
    ds_read_b64_tr_b16 v[156:157], v17 offset:15360
    ds_read_b64_tr_b16 v[158:159], v17 offset:16640
    ds_read_b128 v[140:143], v11 offset:4096
    v_mfma_f32_32x32x16_bf16 v[112:127], v[148:151], v[132:135], v[112:127]
    v_add_u32 v8, s59, v8
    v_add_u32 v9, s59, v9
    v_add_u32 v10, s59, v10
    v_add_u32 v11, s59, v11
    v_add_u32 v16, s59, v16
    v_add_u32 v17, s59, v17
    v_mfma_f32_32x32x16_bf16 v[96:111], v[144:147], v[132:135], v[96:111]
    s_bitcmp1_b32 0x147, s58
    s_waitcnt lgkmcnt(0)
    v_mfma_f32_32x32x16_bf16 v[64:79], v[152:155], v[136:139], v[64:79]
    s_waitcnt vmcnt(4)
    s_cbranch_scc1 P1_XGA
P1_W1GA:
    s_barrier
    ds_read_b128 v[128:131], v8
    ds_read_b64_tr_b16 v[144:145], v16 offset:0
    ds_read_b64_tr_b16 v[146:147], v16 offset:1280
    v_mfma_f32_32x32x16_bf16 v[80:95], v[156:159], v[136:139], v[80:95]
    ds_read_b64_tr_b16 v[148:149], v17 offset:0
    ds_read_b64_tr_b16 v[150:151], v17 offset:1280
    ds_read_b128 v[132:135], v8 offset:4096
    v_mfma_f32_32x32x16_bf16 v[112:127], v[156:159], v[140:143], v[112:127]
    s_add_u32 s60, s60, 1
    s_cmp_eq_u32 s60, 10
    s_cselect_b32 s60, 0, s60
    s_mul_i32 s90, s60, s54
    s_add_u32 s90, s90, s95
    s_add_u32 s91, s91, s57
    v_mfma_f32_32x32x16_bf16 v[96:111], v[152:155], v[140:143], v[96:111]
    s_add_u32 s58, s58, 1
    s_cmp_lt_u32 s58, 9
    s_cbranch_scc1 P1_LGA
    ds_read_b128 v[28:31], v20
    ds_read_b64 v[32:33], v20 offset:16
    ds_read_b128 v[36:39], v20 offset:1024
    ds_read_b64 v[44:45], v23 offset:0
    ds_read_b64 v[46:47], v23 offset:512
    s_waitcnt lgkmcnt(8)
    v_mfma_f32_32x32x16_bf16 v[64:79], v[144:147], v[128:131], v[64:79]
    ds_read_b128 v[136:139], v9
    ds_read_b64_tr_b16 v[152:153], v16 offset:5120
    ds_read_b64_tr_b16 v[154:155], v16 offset:6400
    s_waitcnt lgkmcnt(8)
    v_mfma_f32_32x32x16_bf16 v[80:95], v[148:151], v[128:131], v[80:95]
    ds_read_b64_tr_b16 v[156:157], v17 offset:5120
    ds_read_b64_tr_b16 v[158:159], v17 offset:6400
    ds_read_b128 v[140:143], v9 offset:4096
    v_mfma_f32_32x32x16_bf16 v[112:127], v[148:151], v[132:135], v[112:127]
    v_mfma_f32_32x32x16_bf16 v[96:111], v[144:147], v[132:135], v[96:111]
    s_waitcnt lgkmcnt(3)
    v_mfma_f32_32x32x16_bf16 v[64:79], v[152:155], v[136:139], v[64:79]
    ds_read_b128 v[128:131], v10
    ds_read_b64_tr_b16 v[144:145], v16 offset:10240
    ds_read_b64_tr_b16 v[146:147], v16 offset:11520
    s_waitcnt lgkmcnt(3)
    v_mfma_f32_32x32x16_bf16 v[80:95], v[156:159], v[136:139], v[80:95]
    ds_read_b64_tr_b16 v[148:149], v17 offset:10240
    ds_read_b64_tr_b16 v[150:151], v17 offset:11520
    ds_read_b128 v[132:135], v10 offset:4096
    v_mfma_f32_32x32x16_bf16 v[112:127], v[156:159], v[140:143], v[112:127]
    v_mfma_f32_32x32x16_bf16 v[96:111], v[152:155], v[140:143], v[96:111]
    v_mfma_f32_32x32x8_bf16 v[64:79], v[44:45], v[28:29], v[64:79]
    ds_read_b128 v[136:139], v11
    ds_read_b64_tr_b16 v[152:153], v16 offset:15360
    ds_read_b64_tr_b16 v[154:155], v16 offset:16640
    v_mfma_f32_32x32x8_bf16 v[80:95], v[46:47], v[28:29], v[80:95]
    ds_read_b64_tr_b16 v[156:157], v17 offset:15360
    ds_read_b64_tr_b16 v[158:159], v17 offset:16640
    ds_read_b128 v[140:143], v11 offset:4096
    v_mfma_f32_32x32x8_bf16 v[96:111], v[44:45], v[36:37], v[96:111]
    v_mfma_f32_32x32x8_bf16 v[112:127], v[46:47], v[36:37], v[112:127]
    v_readfirstlane_b32 s97, v33
    s_waitcnt lgkmcnt(3)
    v_mfma_f32_32x32x16_bf16 v[64:79], v[144:147], v[128:131], v[64:79]
    v_mfma_f32_32x32x16_bf16 v[64:79], v[152:155], v[136:139], v[64:79]
    s_waitcnt lgkmcnt(0)
    s_barrier
    v_mfma_f32_32x32x16_bf16 v[80:95], v[148:151], v[128:131], v[80:95]
    v_mfma_f32_32x32x16_bf16 v[80:95], v[156:159], v[136:139], v[80:95]
    s_nop 7
    v_mfma_f32_32x32x16_bf16 v[96:111], v[144:147], v[132:135], v[96:111]
    v_mfma_f32_32x32x16_bf16 v[96:111], v[152:155], v[140:143], v[96:111]
    v_pk_mul_f32 v[64:65], v[64:65], v[30:31]
    v_pk_mul_f32 v[66:67], v[66:67], v[30:31]
    v_pk_mul_f32 v[68:69], v[68:69], v[30:31]
    v_pk_mul_f32 v[70:71], v[70:71], v[30:31]
    v_pk_mul_f32 v[72:73], v[72:73], v[30:31]
    v_pk_mul_f32 v[74:75], v[74:75], v[30:31]
    v_pk_mul_f32 v[76:77], v[76:77], v[30:31]
    v_pk_mul_f32 v[78:79], v[78:79], v[30:31]
    v_cvt_pk_bf16_f32 v160, v64, v65
    v_cvt_pk_bf16_f32 v161, v66, v67
    v_cvt_pk_bf16_f32 v162, v68, v69
    v_cvt_pk_bf16_f32 v163, v70, v71
    v_cvt_pk_bf16_f32 v164, v72, v73
    v_cvt_pk_bf16_f32 v165, v74, v75
    v_cvt_pk_bf16_f32 v166, v76, v77
    v_cvt_pk_bf16_f32 v167, v78, v79
    s_cmp_lt_u32 s27, 4
    s_cbranch_scc1 NR_4
    v_pk_max_i16 v160, v160, 0
    v_pk_max_i16 v161, v161, 0
    v_pk_max_i16 v162, v162, 0
    v_pk_max_i16 v163, v163, 0
    v_pk_max_i16 v164, v164, 0
    v_pk_max_i16 v165, v165, 0
    v_pk_max_i16 v166, v166, 0
    v_pk_max_i16 v167, v167, 0
NR_4:
    s_add_u32 s29, s61, 0
    s_cmp_eq_u32 s97, 0
    s_cbranch_scc1 SLOW_5
    buffer_store_dwordx4 v[160:163], v6, s[4:7], s29 offen offset:0
    buffer_store_dwordx4 v[164:167], v6, s[4:7], s29 offen offset:1024
STD_6:
    v_mfma_f32_32x32x16_bf16 v[112:127], v[148:151], v[132:135], v[112:127]
    v_mfma_f32_32x32x16_bf16 v[112:127], v[156:159], v[140:143], v[112:127]
    v_pk_mul_f32 v[80:81], v[80:81], v[30:31]
    v_pk_mul_f32 v[82:83], v[82:83], v[30:31]
    v_pk_mul_f32 v[84:85], v[84:85], v[30:31]
    v_pk_mul_f32 v[86:87], v[86:87], v[30:31]
    v_pk_mul_f32 v[88:89], v[88:89], v[30:31]
    v_pk_mul_f32 v[90:91], v[90:91], v[30:31]
    v_pk_mul_f32 v[92:93], v[92:93], v[30:31]
    v_pk_mul_f32 v[94:95], v[94:95], v[30:31]
    v_cvt_pk_bf16_f32 v168, v80, v81
    v_cvt_pk_bf16_f32 v169, v82, v83
    v_cvt_pk_bf16_f32 v170, v84, v85
    v_cvt_pk_bf16_f32 v171, v86, v87
    v_cvt_pk_bf16_f32 v172, v88, v89
    v_cvt_pk_bf16_f32 v173, v90, v91
    v_cvt_pk_bf16_f32 v174, v92, v93
    v_cvt_pk_bf16_f32 v175, v94, v95
    s_cmp_lt_u32 s27, 4
    s_cbranch_scc1 NR_7
    v_pk_max_i16 v168, v168, 0
    v_pk_max_i16 v169, v169, 0
    v_pk_max_i16 v170, v170, 0
    v_pk_max_i16 v171, v171, 0
    v_pk_max_i16 v172, v172, 0
    v_pk_max_i16 v173, v173, 0
    v_pk_max_i16 v174, v174, 0
    v_pk_max_i16 v175, v175, 0
NR_7:
    s_add_u32 s29, s61, 2048
    s_cmp_eq_u32 s97, 0
    s_cbranch_scc1 SLOW_8
    buffer_store_dwordx4 v[168:171], v6, s[4:7], s29 offen offset:0
    buffer_store_dwordx4 v[172:175], v6, s[4:7], s29 offen offset:1024
STD_9:
    v_pk_mul_f32 v[96:97], v[96:97], v[38:39]
    v_pk_mul_f32 v[98:99], v[98:99], v[38:39]
    v_pk_mul_f32 v[100:101], v[100:101], v[38:39]
    v_pk_mul_f32 v[102:103], v[102:103], v[38:39]
    v_pk_mul_f32 v[104:105], v[104:105], v[38:39]
    v_pk_mul_f32 v[106:107], v[106:107], v[38:39]
    v_pk_mul_f32 v[108:109], v[108:109], v[38:39]
    v_pk_mul_f32 v[110:111], v[110:111], v[38:39]
    v_cvt_pk_bf16_f32 v176, v96, v97
    v_cvt_pk_bf16_f32 v177, v98, v99
    v_cvt_pk_bf16_f32 v178, v100, v101
    v_cvt_pk_bf16_f32 v179, v102, v103
    v_cvt_pk_bf16_f32 v180, v104, v105
    v_cvt_pk_bf16_f32 v181, v106, v107
    v_cvt_pk_bf16_f32 v182, v108, v109
    v_cvt_pk_bf16_f32 v183, v110, v111
    s_cmp_lt_u32 s27, 4
    s_cbranch_scc1 NR_10
    v_pk_max_i16 v176, v176, 0
    v_pk_max_i16 v177, v177, 0
    v_pk_max_i16 v178, v178, 0
    v_pk_max_i16 v179, v179, 0
    v_pk_max_i16 v180, v180, 0
    v_pk_max_i16 v181, v181, 0
    v_pk_max_i16 v182, v182, 0
    v_pk_max_i16 v183, v183, 0
NR_10:
    s_add_u32 s29, s61, 153600
    s_cmp_eq_u32 s97, 0
    s_cbranch_scc1 SLOW_11
    buffer_store_dwordx4 v[176:179], v6, s[4:7], s29 offen offset:0
    buffer_store_dwordx4 v[180:183], v6, s[4:7], s29 offen offset:1024
STD_12:
    v_pk_mul_f32 v[112:113], v[112:113], v[38:39]
    v_pk_mul_f32 v[114:115], v[114:115], v[38:39]
    v_pk_mul_f32 v[116:117], v[116:117], v[38:39]
    v_pk_mul_f32 v[118:119], v[118:119], v[38:39]
    v_pk_mul_f32 v[120:121], v[120:121], v[38:39]
    v_pk_mul_f32 v[122:123], v[122:123], v[38:39]
    v_pk_mul_f32 v[124:125], v[124:125], v[38:39]
    v_pk_mul_f32 v[126:127], v[126:127], v[38:39]
    v_cvt_pk_bf16_f32 v184, v112, v113
    v_cvt_pk_bf16_f32 v185, v114, v115
    v_cvt_pk_bf16_f32 v186, v116, v117
    v_cvt_pk_bf16_f32 v187, v118, v119
    v_cvt_pk_bf16_f32 v188, v120, v121
    v_cvt_pk_bf16_f32 v189, v122, v123
    v_cvt_pk_bf16_f32 v190, v124, v125
    v_cvt_pk_bf16_f32 v191, v126, v127
    s_cmp_lt_u32 s27, 4
    s_cbranch_scc1 NR_13
    v_pk_max_i16 v184, v184, 0
    v_pk_max_i16 v185, v185, 0
    v_pk_max_i16 v186, v186, 0
    v_pk_max_i16 v187, v187, 0
    v_pk_max_i16 v188, v188, 0
    v_pk_max_i16 v189, v189, 0
    v_pk_max_i16 v190, v190, 0
    v_pk_max_i16 v191, v191, 0
NR_13:
    s_add_u32 s29, s61, 155648
    s_cmp_eq_u32 s97, 0
    s_cbranch_scc1 SLOW_14
    buffer_store_dwordx4 v[184:187], v6, s[4:7], s29 offen offset:0
    buffer_store_dwordx4 v[188:191], v6, s[4:7], s29 offen offset:1024
STD_15:
    s_lshl_b32 s29, s24, 2
    s_add_u32 s29, s29, s62
    s_mov_b64 exec, 1
    s_waitcnt vmcnt(0)
    s_cmp_eq_u32 s97, 0
    s_cbranch_scc1 SLOW_16
    buffer_store_dword v32, v7, s[4:7], s29 offen offset:32
STD_17:
    s_mov_b64 exec, -1
    s_branch P2_FFN
P1_XGA:
    s_cmp_lg_u32 s58, 0
    s_cbranch_scc1 XH_18
    v_mov_b64 v[202:203], 0
    v_dot2c_f32_bf16 v202, v24, v192
    v_dot2c_f32_bf16 v203, v192, v192
    v_dot2c_f32_bf16 v202, v24, v193
    v_dot2c_f32_bf16 v203, v193, v193
    v_dot2c_f32_bf16 v202, v24, v194
    v_dot2c_f32_bf16 v203, v194, v194
    v_dot2c_f32_bf16 v202, v24, v195
    v_dot2c_f32_bf16 v203, v195, v195
    v_dot2c_f32_bf16 v202, v24, v196
    v_dot2c_f32_bf16 v203, v196, v196
    v_dot2c_f32_bf16 v202, v24, v197
    v_dot2c_f32_bf16 v203, v197, v197
    v_dot2c_f32_bf16 v202, v24, v198
    v_dot2c_f32_bf16 v203, v198, v198
    v_dot2c_f32_bf16 v202, v24, v199
    v_dot2c_f32_bf16 v203, v199, v199
    v_dot2c_f32_bf16 v202, v24, v200
    v_dot2c_f32_bf16 v203, v200, v200
    v_dot2c_f32_bf16 v202, v24, v201
    v_dot2c_f32_bf16 v203, v201, v201
    s_nop 2
    v_add_f32_dpp v202, v202, v202 row_shr:1 row_mask:0xf bank_mask:0xf bound_ctrl:0
    v_add_f32_dpp v203, v203, v203 row_shr:1 row_mask:0xf bank_mask:0xf bound_ctrl:0
    s_nop 0
    v_add_f32_dpp v202, v202, v202 row_shr:2 row_mask:0xf bank_mask:0xf bound_ctrl:0
    v_add_f32_dpp v203, v203, v203 row_shr:2 row_mask:0xf bank_mask:0xf bound_ctrl:0
    s_nop 0
    v_add_f32_dpp v202, v202, v202 row_shr:4 row_mask:0xf bank_mask:0xf bound_ctrl:0
    v_add_f32_dpp v203, v203, v203 row_shr:4 row_mask:0xf bank_mask:0xf bound_ctrl:0
    s_nop 0
    v_add_f32_dpp v202, v202, v202 row_shr:8 row_mask:0xf bank_mask:0xf bound_ctrl:0
    v_add_f32_dpp v203, v203, v203 row_shr:8 row_mask:0xf bank_mask:0xf bound_ctrl:0
    s_nop 0
    v_add_f32_dpp v202, v202, v202 row_bcast:15 row_mask:0xa bank_mask:0xf
    v_add_f32_dpp v203, v203, v203 row_bcast:15 row_mask:0xa bank_mask:0xf
    buffer_load_dword v21, v7, s[20:23], 0 offen sc1
    s_branch P1_W1GA
XH_18:
    s_cmp_lg_u32 s58, 1
    s_cbranch_scc1 XH_19
    v_mul_f32 v202, 0x3acccccd, v202
    v_mul_f32 v203, 0x3acccccd, v203
    v_fma_f32 v203, -v202, v202, v203
    v_max_f32 v203, 0, v203
    v_cvt_pk_bf16_f32 v204, -v202, -v202
    v_cvt_pk_bf16_f32 v203, v203, v203
    v_and_b32 v203, 0xffff0000, v203
    v_add_f32 v203, 0x3727c5ac, v203
    v_cvt_pk_bf16_f32 v203, v203, v203
    v_and_b32 v203, 0xffff0000, v203
    v_sqrt_f32 v203, v203
    s_nop 0
    v_cvt_pk_bf16_f32 v203, v203, v203
    v_and_b32 v203, 0xffff0000, v203
    v_rcp_f32 v206, v203
    s_branch P1_W1GA
XH_19:
    s_cmp_lg_u32 s58, 2
    s_cbranch_scc1 XH_20
    s_mov_b32 s99, 262144
NON_21:
    v_readfirstlane_b32 s25, v21
    s_cmp_lg_u32 s25, 0
    s_cbranch_scc1 NOND_22
    buffer_load_dword v21, v7, s[20:23], 0 offen sc1
    s_waitcnt vmcnt(0)
    s_sub_u32 s99, s99, 1
    s_cbranch_scc0 NON_21
NOND_22:
    s_getreg_b32 s53, hwreg(HW_REG_XCC_ID, 0, 4)
    s_lshl_b32 s53, s53, 1
    s_xor_b32 s53, s53, s25
    s_cmp_lg_u32 s24, 0
    s_cbranch_scc1 XW_23
    s_and_b32 s29, s2, 7
    s_lshl_b32 s29, s29, 5
    s_lshr_b32 s30, s2, 3
    s_add_u32 s29, s29, s30
    s_lshl_b32 s29, s29, 2
    s_add_u32 s29, s29, 13082624
    v_mov_b32 v5, s53
    s_mov_b64 exec, 1
    buffer_store_dword v5, v7, s[4:7], s29 offen sc1
    s_mov_b64 exec, -1
XW_23:
    v_mov_b32 v205, v21
    v_mov_b32 v207, v21
    v_lshlrev_b32 v5, 4, v3
    s_lshl_b32 s29, s56, 5
    s_add_u32 s29, s29, 12656640
    s_mov_b32 exec_lo, 0x80000000
    s_mov_b32 exec_hi, 0x80000000
    buffer_store_dwordx4 v[204:207], v5, s[4:7], s29 offen sc1
    s_mov_b64 exec, -1
    s_branch P1_W1GA
XH_20:
    s_cmp_lg_u32 s58, 8
    s_cbranch_scc1 XH_24
    s_waitcnt vmcnt(3)
    s_branch P1_W1GA
XH_24:
    s_mov_b64 vcc, 0
    s_mul_i32 s29, s87, 10240
    s_add_u32 s29, s29, s92
    s_mul_i32 s30, s28, 2560
    s_add_u32 s29, s29, s30
    s_mov_b64 exec, 0xfffff
    buffer_load_dword v229, v4, s[4:7], s29 offen sc1
    s_mov_b64 exec, 0x7f
    buffer_load_dword v230, v4, s[12:15], s55 offen
    s_mov_b64 exec, 0x3ffff
    buffer_load_dword v231, v4, s[16:19], s51 offen
    s_mov_b64 exec, -1
    s_branch P1_W1GA
P1_GB:
    s_mov_b32 s4, s52
    s_mov_b32 s5, s53
    s_mov_b32 s6, 13083648
    s_mov_b32 s7, 0x00020000
    s_mov_b32 s20, s50
    s_mov_b32 s21, s51
    s_mov_b32 s22, 256
    s_mov_b32 s23, 0x00020000
    v_mov_b32 v7, 0
    v_mov_b64 v[52:53], 0
    v_mov_b64 v[54:55], 0
    v_and_b32 v2, 31, v1
    v_lshrrev_b32 v3, 5, v1
    v_mfma_f32_32x32x8_bf16 v[180:195], v[52:53], v[52:53], 0
    v_mfma_f32_32x32x8_bf16 v[212:227], v[52:53], v[52:53], 0
    v_mov_b32 v24, 0x3f803f80
    v_mov_b32 v25, 0x3f803f80
    v_bfe_u32 v4, v1, 1, 3
    v_xor_b32 v4, v4, v3
    s_lshl_b32 s29, s28, 12
    s_add_u32 s29, s29, 20480
    v_lshl_add_u32 v5, v2, 7, s29
    v_xor_b32 v6, 0, v4
    v_lshl_add_u32 v8, v6, 4, v5
    v_xor_b32 v6, 2, v4
    v_lshl_add_u32 v9, v6, 4, v5
    v_xor_b32 v6, 4, v4
    v_lshl_add_u32 v10, v6, 4, v5
    v_xor_b32 v6, 6, v4
    v_lshl_add_u32 v11, v6, 4, v5
    v_bfe_u32 v4, v1, 2, 2
    v_lshl_add_u32 v22, v3, 3, v4
    v_bfe_u32 v26, v1, 4, 1
    v_and_b32 v27, 3, v1
    v_mul_u32_u24 v22, 320, v22
    s_cmp_lt_u32 s27, 4
    s_cselect_b32 s29, 32, 0x100
    s_cselect_b32 s30, 160, 32
    s_cselect_b32 s31, 40, 8
    v_mad_u32_u24 v12, v27, s31, v22
    v_mad_u32_u24 v12, v26, s30, v12
    v_add_u32 v12, s29, v12
    s_cmp_lt_u32 s27, 4
    s_cselect_b32 s30, 40, 32
    s_lshl_b32 s29, s30, 1
    s_mul_i32 s29, s29, s28
    v_lshl_add_u32 v13, v27, 3, v22
    v_mad_u32_u24 v13, v26, s30, v13
    v_add_u32 v13, s29, v13
    s_sub_u32 s29, s27, 4
    s_cmp_lt_u32 s27, 4
    s_mov_b32 s31, 3456
    s_cmov_b32 s31, 1280
    s_cselect_b32 s29, s27, s29
    s_mul_i32 s29, s29, 320
    s_lshl_b32 s95, s28, 4
    s_mul_i32 s95, s95, s31
    s_add_u32 s95, s95, s29
    s_lshl_b32 s54, s31, 6
    s_sub_u32 s31, s31, 320
    v_add_u32 v4, 0, v1
    v_mul_u32_u24 v5, 3277, v4
    v_lshrrev_b32 v5, 16, v5
    v_lshlrev_b32 v4, 4, v1
    v_mad_u32_u24 v56, v5, s31, v4
    v_add_u32 v4, 64, v1
    v_mul_u32_u24 v5, 3277, v4
    v_lshrrev_b32 v5, 16, v5
    v_lshlrev_b32 v4, 4, v1
    v_mad_u32_u24 v57, v5, s31, v4
    v_add_u32 v4, 128, v1
    v_mul_u32_u24 v5, 3277, v4
    v_lshrrev_b32 v5, 16, v5
    v_lshlrev_b32 v4, 4, v1
    v_mad_u32_u24 v58, v5, s31, v4
    v_add_u32 v4, 192, v1
    v_mul_u32_u24 v5, 3277, v4
    v_lshrrev_b32 v5, 16, v5
    v_lshlrev_b32 v4, 4, v1
    v_mad_u32_u24 v59, v5, s31, v4
    v_add_u32 v4, 256, v1
    v_mul_u32_u24 v5, 3277, v4
    v_lshrrev_b32 v5, 16, v5
    v_lshlrev_b32 v4, 4, v4
    v_mad_u32_u24 v60, v5, s31, v4
    s_mul_i32 s90, s60, s54
    s_add_u32 s90, s90, s95
    s_mul_i32 s91, s28, 5120
    s_cmp_lt_u32 s27, 4
    s_cselect_b32 s8, s34, s44
    s_cselect_b32 s9, s35, s45
    s_mov_b32 s10, 2211840
    s_cmov_b32 s10, 819200
    s_mov_b32 s11, 0x00020000
    s_add_u32 s60, s60, 1
    s_cmp_eq_u32 s60, 10
    s_cselect_b32 s60, 0, s60
    s_lshl_b32 s55, s60, 7
    s_add_u32 s57, s57, 36864
    s_mul_i32 s90, s60, s54
    s_add_u32 s90, s90, s95
    s_add_u32 s91, s91, 36864
    s_add_u32 m0, s57, 0
    s_nop 0
    buffer_load_dwordx4 v16, s[16:19], s55 offen lds
    buffer_load_dwordx4 v17, s[16:19], s55 offen offset:1024 lds
    buffer_load_dwordx4 v18, s[16:19], s55 offen offset:2048 lds
    buffer_load_dwordx4 v19, s[16:19], s55 offen offset:3072 lds
    s_add_u32 s60, s60, 1
    s_cmp_eq_u32 s60, 10
    s_cselect_b32 s60, 0, s60
    s_lshl_b32 s55, s60, 7
    s_add_u32 s57, s57, 36864
    s_mul_i32 s90, s60, s54
    s_add_u32 s90, s90, s95
    s_add_u32 s91, s91, 36864
    s_and_b32 s86, s2, 7
    s_lshl_b32 s86, s86, 3
    s_lshr_b32 s29, s2, 5
    s_add_u32 s86, s86, s29
    s_bfe_u32 s87, s2, 0x20003
    s_mul_i32 s92, s86, 153600
    s_mul_i32 s93, s86, 40960
    s_mul_i32 s29, s87, 320
    s_add_u32 s93, s93, s29
    s_lshl_b32 s94, s86, 2
    s_add_u32 s94, s94, s87
    s_lshl_b32 s94, s94, 7
    s_add_u32 s94, s94, 13049856
    s_mul_i32 s61, s96, 153600
    s_mul_i32 s29, s27, 10240
    s_add_u32 s61, s61, s29
    s_cmp_lt_u32 s27, 4
    s_cselect_b32 s63, 0x3ea52b5c, 1.0
    s_lshl_b32 s62, s26, 4
    s_add_u32 s62, s62, s27
    s_lshl_b32 s62, s62, 7
    s_add_u32 s62, s62, 13017088
    s_mov_b32 s97, 0
    s_mov_b32 s58, 0
    s_mov_b32 s12, s48
    s_mov_b32 s13, s49
    s_mov_b32 s14, 2621440
    s_mov_b32 s15, 0x00020000
    v_mov_b32 v4, 157696
    ds_write_b128 v4, v[52:55]
    s_lshl_b32 s51, s27, 2
    s_add_u32 s51, s51, s28
    s_mul_i32 s51, s51, 5120
    s_add_u32 s51, s51, 12689408
    s_sub_u32 s57, s57, 73728
    s_sub_u32 s91, s91, 73728
    s_setprio 1
    s_waitcnt vmcnt(4)
    s_barrier
    ds_read_b128 v[28:31], v8
    ds_read_b64_tr_b16 v[36:37], v12 offset:0
    ds_read_b64_tr_b16 v[38:39], v12 offset:1280
    s_add_u32 m0, s91, 73728
    s_nop 0
    buffer_load_dwordx4 v58, s[8:11], s90 offen offset:2048 lds
    buffer_load_dwordx4 v59, s[8:11], s90 offen offset:3072 lds
    s_add_u32 m0, s91, 77824
    s_nop 0
    buffer_load_dwordx4 v60, s[8:11], s90 offen lds
    s_add_u32 m0, s57, 73728
    s_nop 0
    buffer_load_dwordx4 v16, s[16:19], s55 offen lds
    buffer_load_dwordx4 v17, s[16:19], s55 offen offset:1024 lds
    buffer_load_dwordx4 v18, s[16:19], s55 offen offset:2048 lds
    buffer_load_dwordx4 v19, s[16:19], s55 offen offset:3072 lds
    buffer_load_dword v21, v7, s[20:23], 0 offen sc1
    s_add_u32 s60, s60, 1
    s_cmp_eq_u32 s60, 10
    s_cselect_b32 s60, 0, s60
    s_lshl_b32 s55, s60, 7
    s_mul_i32 s90, s60, s54
    s_add_u32 s90, s90, s95
    ds_read_b64_tr_b16 v[196:197], v13 offset:0
    ds_read_b64_tr_b16 v[198:199], v13 offset:1280
    s_waitcnt lgkmcnt(0)
    v_mfma_f32_32x32x16_bf16 v[180:195], v[36:39], v[28:31], v[180:195]
    v_mfma_f32_4x4x4_16b_bf16 v[212:215], v[24:25], v[196:197], v[212:215]
    v_mfma_f32_4x4x4_16b_bf16 v[216:219], v[24:25], v[36:37], v[216:219]
    v_mfma_f32_4x4x4_16b_bf16 v[220:223], v[24:25], v[198:199], v[220:223]
    v_mfma_f32_4x4x4_16b_bf16 v[224:227], v[24:25], v[38:39], v[224:227]
    ds_read_b128 v[32:35], v9
    ds_read_b64_tr_b16 v[40:41], v12 offset:5120
    ds_read_b64_tr_b16 v[42:43], v12 offset:6400
    s_add_u32 m0, s91, 110592
    s_nop 0
    buffer_load_dwordx4 v58, s[8:11], s90 offen offset:2048 lds
    buffer_load_dwordx4 v59, s[8:11], s90 offen offset:3072 lds
    s_add_u32 m0, s91, 114688
    s_nop 0
    buffer_load_dwordx4 v60, s[8:11], s90 offen lds
    ds_read_b64_tr_b16 v[196:197], v13 offset:5120
    ds_read_b64_tr_b16 v[198:199], v13 offset:6400
    s_waitcnt lgkmcnt(0)
    v_mfma_f32_32x32x16_bf16 v[180:195], v[40:43], v[32:35], v[180:195]
    v_mfma_f32_4x4x4_16b_bf16 v[212:215], v[24:25], v[196:197], v[212:215]
    v_mfma_f32_4x4x4_16b_bf16 v[216:219], v[24:25], v[40:41], v[216:219]
    v_mfma_f32_4x4x4_16b_bf16 v[220:223], v[24:25], v[198:199], v[220:223]
    v_mfma_f32_4x4x4_16b_bf16 v[224:227], v[24:25], v[42:43], v[224:227]
    ds_read_b128 v[28:31], v10
    ds_read_b64_tr_b16 v[36:37], v12 offset:10240
    ds_read_b64_tr_b16 v[38:39], v12 offset:11520
    s_add_u32 m0, s57, 110592
    s_nop 0
    buffer_load_dwordx4 v16, s[16:19], s55 offen lds
    buffer_load_dwordx4 v17, s[16:19], s55 offen offset:1024 lds
    ds_read_b64_tr_b16 v[196:197], v13 offset:10240
    ds_read_b64_tr_b16 v[198:199], v13 offset:11520
    s_waitcnt lgkmcnt(0)
    v_mfma_f32_32x32x16_bf16 v[180:195], v[36:39], v[28:31], v[180:195]
    v_mfma_f32_4x4x4_16b_bf16 v[212:215], v[24:25], v[196:197], v[212:215]
    v_mfma_f32_4x4x4_16b_bf16 v[216:219], v[24:25], v[36:37], v[216:219]
    v_mfma_f32_4x4x4_16b_bf16 v[220:223], v[24:25], v[198:199], v[220:223]
    v_mfma_f32_4x4x4_16b_bf16 v[224:227], v[24:25], v[38:39], v[224:227]
    ds_read_b128 v[32:35], v11
    ds_read_b64_tr_b16 v[40:41], v12 offset:15360
    ds_read_b64_tr_b16 v[42:43], v12 offset:16640
    buffer_load_dwordx4 v18, s[16:19], s55 offen offset:2048 lds
    buffer_load_dwordx4 v19, s[16:19], s55 offen offset:3072 lds
    ds_read_b64_tr_b16 v[196:197], v13 offset:15360
    ds_read_b64_tr_b16 v[198:199], v13 offset:16640
    v_add_u32 v8, 36864, v8
    v_add_u32 v9, 36864, v9
    v_add_u32 v10, 36864, v10
    v_add_u32 v11, 36864, v11
    v_add_u32 v12, 36864, v12
    s_waitcnt lgkmcnt(0)
    v_mfma_f32_32x32x16_bf16 v[180:195], v[40:43], v[32:35], v[180:195]
    v_mfma_f32_4x4x4_16b_bf16 v[212:215], v[24:25], v[196:197], v[212:215]
    v_mfma_f32_4x4x4_16b_bf16 v[216:219], v[24:25], v[40:41], v[216:219]
    v_mfma_f32_4x4x4_16b_bf16 v[220:223], v[24:25], v[198:199], v[220:223]
    v_mfma_f32_4x4x4_16b_bf16 v[224:227], v[24:25], v[42:43], v[224:227]
    s_waitcnt vmcnt(15)
    s_barrier
    ds_read_b128 v[28:31], v8
    ds_read_b64_tr_b16 v[36:37], v12 offset:0
    ds_read_b64_tr_b16 v[38:39], v12 offset:1280
    s_add_u32 s60, s60, 1
    s_cmp_eq_u32 s60, 10
    s_cselect_b32 s60, 0, s60
    s_lshl_b32 s55, s60, 7
    s_mul_i32 s90, s60, s54
    s_add_u32 s90, s90, s95
    s_waitcnt lgkmcnt(0)
    v_mfma_f32_32x32x16_bf16 v[180:195], v[36:39], v[28:31], v[180:195]
    ds_read_b128 v[32:35], v9
    ds_read_b64_tr_b16 v[40:41], v12 offset:5120
    ds_read_b64_tr_b16 v[42:43], v12 offset:6400
    s_add_u32 m0, s91, 0
    s_nop 0
    buffer_load_dwordx4 v58, s[8:11], s90 offen offset:2048 lds
    buffer_load_dwordx4 v59, s[8:11], s90 offen offset:3072 lds
    s_add_u32 m0, s91, 4096
    s_nop 0
    buffer_load_dwordx4 v60, s[8:11], s90 offen lds
    s_waitcnt lgkmcnt(0)
    v_mfma_f32_32x32x16_bf16 v[180:195], v[40:43], v[32:35], v[180:195]
    ds_read_b128 v[28:31], v10
    ds_read_b64_tr_b16 v[36:37], v12 offset:10240
    ds_read_b64_tr_b16 v[38:39], v12 offset:11520
    s_add_u32 m0, s57, 0
    s_nop 0
    buffer_load_dwordx4 v16, s[16:19], s55 offen lds
    buffer_load_dwordx4 v17, s[16:19], s55 offen offset:1024 lds
    s_movk_i32 s31, 960
    v_add_u32 v4, 256, v1
    v_mul_u32_u24 v5, 3277, v4
    v_lshrrev_b32 v5, 16, v5
    v_lshlrev_b32 v4, 4, v4
    v_mad_u32_u24 v204, v5, s31, v4
    v_and_b32 v4, 15, v1
    v_lshlrev_b32 v4, 11, v4
    v_add_u32 v4, 13019008, v4
    s_and_b32 s29, s2, 7
    s_lshl_b32 s29, s29, 7
    s_add_u32 s29, s29, 13082624
    v_cmp_gt_u32 vcc, 32, v1
    v_lshl_add_u32 v5, v2, 2, s29
    s_nop 0
    v_cndmask_b32 v23, v5, v4, vcc
    s_waitcnt lgkmcnt(0)
    v_mfma_f32_32x32x16_bf16 v[180:195], v[36:39], v[28:31], v[180:195]
    ds_read_b128 v[32:35], v11
    ds_read_b64_tr_b16 v[40:41], v12 offset:15360
    ds_read_b64_tr_b16 v[42:43], v12 offset:16640
    buffer_load_dwordx4 v18, s[16:19], s55 offen offset:2048 lds
    buffer_load_dwordx4 v19, s[16:19], s55 offen offset:3072 lds
    v_add_u32 v8, 36864, v8
    v_add_u32 v9, 36864, v9
    v_add_u32 v10, 36864, v10
    v_add_u32 v11, 36864, v11
    v_add_u32 v12, 36864, v12
    s_waitcnt lgkmcnt(0)
    v_mfma_f32_32x32x16_bf16 v[180:195], v[40:43], v[32:35], v[180:195]
    s_waitcnt vmcnt(14)
    s_barrier
    ds_read_b128 v[28:31], v8
    ds_read_b64_tr_b16 v[36:37], v12 offset:0
    ds_read_b64_tr_b16 v[38:39], v12 offset:1280
    s_add_u32 s60, s60, 1
    s_cmp_eq_u32 s60, 10
    s_cselect_b32 s60, 0, s60
    s_lshl_b32 s55, s60, 7
    s_mul_i32 s90, s60, s54
    s_add_u32 s90, s90, s95
    s_waitcnt lgkmcnt(0)
    v_mfma_f32_32x32x16_bf16 v[180:195], v[36:39], v[28:31], v[180:195]
    ds_read_b128 v[32:35], v9
    ds_read_b64_tr_b16 v[40:41], v12 offset:5120
    ds_read_b64_tr_b16 v[42:43], v12 offset:6400
    s_add_u32 m0, s91, 36864
    s_nop 0
    buffer_load_dwordx4 v58, s[8:11], s90 offen offset:2048 lds
    buffer_load_dwordx4 v59, s[8:11], s90 offen offset:3072 lds
    s_add_u32 m0, s91, 40960
    s_nop 0
    buffer_load_dwordx4 v60, s[8:11], s90 offen lds
    s_mov_b32 s99, 262144
NON_25:
    v_readfirstlane_b32 s25, v21
    s_cmp_lg_u32 s25, 0
    s_cbranch_scc1 NOND_26
    buffer_load_dword v21, v7, s[20:23], 0 offen sc1
    s_waitcnt vmcnt(0)
    s_sub_u32 s99, s99, 1
    s_cbranch_scc0 NON_25
NOND_26:
    s_getreg_b32 s53, hwreg(HW_REG_XCC_ID, 0, 4)
    s_lshl_b32 s53, s53, 1
    s_xor_b32 s53, s53, s25
    s_waitcnt lgkmcnt(0)
    v_mfma_f32_32x32x16_bf16 v[180:195], v[40:43], v[32:35], v[180:195]
    ds_read_b128 v[28:31], v10
    ds_read_b64_tr_b16 v[36:37], v12 offset:10240
    ds_read_b64_tr_b16 v[38:39], v12 offset:11520
    s_add_u32 m0, s57, 36864
    s_nop 0
    buffer_load_dwordx4 v16, s[16:19], s55 offen lds
    buffer_load_dwordx4 v17, s[16:19], s55 offen offset:1024 lds
    v_add_f32 v52, v212, v220
    v_add_f32 v54, v216, v224
    v_mov_b32 v4, v52
    s_nop 1
    v_permlane32_swap_b32 v4, v52
    v_add_f32 v52, v52, v4
    v_mov_b32 v4, v54
    s_nop 1
    v_permlane32_swap_b32 v4, v54
    v_add_f32 v54, v54, v4
    v_mov_b32 v53, v21
    v_mov_b32 v55, v21
    v_lshlrev_b32 v6, 4, v1
    s_lshl_b32 s30, s98, 9
    s_add_u32 s29, s51, s30
    s_mov_b32 exec_hi, 0
    buffer_store_dwordx4 v[52:55], v6, s[4:7], s29 offen sc1
    s_mov_b32 exec_hi, -1
    s_waitcnt lgkmcnt(0)
    v_mfma_f32_32x32x16_bf16 v[180:195], v[36:39], v[28:31], v[180:195]
    ds_read_b128 v[32:35], v11
    ds_read_b64_tr_b16 v[40:41], v12 offset:15360
    ds_read_b64_tr_b16 v[42:43], v12 offset:16640
    buffer_load_dwordx4 v18, s[16:19], s55 offen offset:2048 lds
    buffer_load_dwordx4 v19, s[16:19], s55 offen offset:3072 lds
    v_add_u32 v8, 36864, v8
    v_add_u32 v9, 36864, v9
    v_add_u32 v10, 36864, v10
    v_add_u32 v11, 36864, v11
    v_add_u32 v12, 36864, v12
    s_waitcnt lgkmcnt(0)
    v_mfma_f32_32x32x16_bf16 v[180:195], v[40:43], v[32:35], v[180:195]
    s_waitcnt vmcnt(15)
    s_barrier
    ds_read_b128 v[28:31], v8
    ds_read_b64_tr_b16 v[36:37], v12 offset:0
    ds_read_b64_tr_b16 v[38:39], v12 offset:1280
    s_add_u32 s60, s60, 1
    s_cmp_eq_u32 s60, 10
    s_cselect_b32 s60, 0, s60
    s_lshl_b32 s55, s60, 7
    s_mul_i32 s90, s60, s54
    s_add_u32 s90, s90, s95
    s_waitcnt lgkmcnt(0)
    v_mfma_f32_32x32x16_bf16 v[180:195], v[36:39], v[28:31], v[180:195]
    ds_read_b128 v[32:35], v9
    ds_read_b64_tr_b16 v[40:41], v12 offset:5120
    ds_read_b64_tr_b16 v[42:43], v12 offset:6400
    s_add_u32 m0, s91, 73728
    s_nop 0
    buffer_load_dwordx4 v58, s[8:11], s90 offen offset:2048 lds
    buffer_load_dwordx4 v59, s[8:11], s90 offen offset:3072 lds
    s_add_u32 m0, s91, 77824
    s_nop 0
    buffer_load_dwordx4 v60, s[8:11], s90 offen lds
    s_waitcnt lgkmcnt(0)
    v_mfma_f32_32x32x16_bf16 v[180:195], v[40:43], v[32:35], v[180:195]
    ds_read_b128 v[28:31], v10
    ds_read_b64_tr_b16 v[36:37], v12 offset:10240
    ds_read_b64_tr_b16 v[38:39], v12 offset:11520
    s_add_u32 m0, s57, 73728
    s_nop 0
    buffer_load_dwordx4 v16, s[16:19], s55 offen lds
    buffer_load_dwordx4 v17, s[16:19], s55 offen offset:1024 lds
    s_movk_i32 s31, 960
    v_add_u32 v4, 0, v1
    v_mul_u32_u24 v5, 3277, v4
    v_lshrrev_b32 v5, 16, v5
    v_lshlrev_b32 v4, 4, v1
    v_mad_u32_u24 v200, v5, s31, v4
    v_add_u32 v4, 64, v1
    v_mul_u32_u24 v5, 3277, v4
    v_lshrrev_b32 v5, 16, v5
    v_lshlrev_b32 v4, 4, v1
    v_mad_u32_u24 v201, v5, s31, v4
    s_waitcnt lgkmcnt(0)
    v_mfma_f32_32x32x16_bf16 v[180:195], v[36:39], v[28:31], v[180:195]
    ds_read_b128 v[32:35], v11
    ds_read_b64_tr_b16 v[40:41], v12 offset:15360
    ds_read_b64_tr_b16 v[42:43], v12 offset:16640
    buffer_load_dwordx4 v18, s[16:19], s55 offen offset:2048 lds
    buffer_load_dwordx4 v19, s[16:19], s55 offen offset:3072 lds
    v_add_u32 v8, -110592, v8
    v_add_u32 v9, -110592, v9
    v_add_u32 v10, -110592, v10
    v_add_u32 v11, -110592, v11
    v_add_u32 v12, -110592, v12
    s_waitcnt lgkmcnt(0)
    v_mfma_f32_32x32x16_bf16 v[180:195], v[40:43], v[32:35], v[180:195]
    s_waitcnt vmcnt(15)
    s_barrier
    ds_read_b128 v[28:31], v8
    ds_read_b64_tr_b16 v[36:37], v12 offset:0
    ds_read_b64_tr_b16 v[38:39], v12 offset:1280
    s_add_u32 s60, s60, 1
    s_cmp_eq_u32 s60, 10
    s_cselect_b32 s60, 0, s60
    s_lshl_b32 s55, s60, 7
    s_mul_i32 s90, s60, s54
    s_add_u32 s90, s90, s95
    s_waitcnt lgkmcnt(0)
    v_mfma_f32_32x32x16_bf16 v[180:195], v[36:39], v[28:31], v[180:195]
    ds_read_b128 v[32:35], v9
    ds_read_b64_tr_b16 v[40:41], v12 offset:5120
    ds_read_b64_tr_b16 v[42:43], v12 offset:6400
    s_add_u32 m0, s91, 110592
    s_nop 0
    buffer_load_dwordx4 v58, s[8:11], s90 offen offset:2048 lds
    buffer_load_dwordx4 v59, s[8:11], s90 offen offset:3072 lds
    s_add_u32 m0, s91, 114688
    s_nop 0
    buffer_load_dwordx4 v60, s[8:11], s90 offen lds
    s_waitcnt lgkmcnt(0)
    v_mfma_f32_32x32x16_bf16 v[180:195], v[40:43], v[32:35], v[180:195]
    ds_read_b128 v[28:31], v10
    ds_read_b64_tr_b16 v[36:37], v12 offset:10240
    ds_read_b64_tr_b16 v[38:39], v12 offset:11520
    s_add_u32 m0, s57, 110592
    s_nop 0
    buffer_load_dwordx4 v16, s[16:19], s55 offen lds
    buffer_load_dwordx4 v17, s[16:19], s55 offen offset:1024 lds
    s_movk_i32 s31, 960
    v_add_u32 v4, 128, v1
    v_mul_u32_u24 v5, 3277, v4
    v_lshrrev_b32 v5, 16, v5
    v_lshlrev_b32 v4, 4, v1
    v_mad_u32_u24 v202, v5, s31, v4
    v_add_u32 v4, 192, v1
    v_mul_u32_u24 v5, 3277, v4
    v_lshrrev_b32 v5, 16, v5
    v_lshlrev_b32 v4, 4, v1
    v_mad_u32_u24 v203, v5, s31, v4
    s_waitcnt lgkmcnt(0)
    v_mfma_f32_32x32x16_bf16 v[180:195], v[36:39], v[28:31], v[180:195]
    ds_read_b128 v[32:35], v11
    ds_read_b64_tr_b16 v[40:41], v12 offset:15360
    ds_read_b64_tr_b16 v[42:43], v12 offset:16640
    buffer_load_dwordx4 v18, s[16:19], s55 offen offset:2048 lds
    buffer_load_dwordx4 v19, s[16:19], s55 offen offset:3072 lds
    buffer_load_dword v22, v23, s[4:7], 0 offen sc1
    v_add_u32 v8, 36864, v8
    v_add_u32 v9, 36864, v9
    v_add_u32 v10, 36864, v10
    v_add_u32 v11, 36864, v11
    v_add_u32 v12, 36864, v12
    s_waitcnt lgkmcnt(0)
    v_mfma_f32_32x32x16_bf16 v[180:195], v[40:43], v[32:35], v[180:195]
    s_waitcnt vmcnt(15)
    s_barrier
    ds_read_b128 v[28:31], v8
    ds_read_b64_tr_b16 v[36:37], v12 offset:0
    ds_read_b64_tr_b16 v[38:39], v12 offset:1280
    s_add_u32 s60, s60, 1
    s_cmp_eq_u32 s60, 10
    s_cselect_b32 s60, 0, s60
    s_lshl_b32 s55, s60, 7
    s_mul_i32 s90, s60, s54
    s_add_u32 s90, s90, s95
    s_waitcnt lgkmcnt(0)
    v_mfma_f32_32x32x16_bf16 v[180:195], v[36:39], v[28:31], v[180:195]
    ds_read_b128 v[32:35], v9
    ds_read_b64_tr_b16 v[40:41], v12 offset:5120
    ds_read_b64_tr_b16 v[42:43], v12 offset:6400
    s_add_u32 m0, s91, 0
    s_nop 0
    buffer_load_dwordx4 v58, s[8:11], s90 offen offset:2048 lds
    buffer_load_dwordx4 v59, s[8:11], s90 offen offset:3072 lds
    s_add_u32 m0, s91, 4096
    s_nop 0
    buffer_load_dwordx4 v60, s[8:11], s90 offen lds
    s_lshl_b32 s29, s96, 9
    s_add_u32 s29, s29, 12656640
    v_lshlrev_b32 v4, 4, v2
    buffer_load_dwordx4 v[206:209], v4, s[4:7], s29 offen sc1
    v_mul_u32_u24 v5, 2560, v3
    v_add_u32 v13, v4, v5
    s_waitcnt lgkmcnt(0)
    v_mfma_f32_32x32x16_bf16 v[180:195], v[40:43], v[32:35], v[180:195]
    ds_read_b128 v[28:31], v10
    ds_read_b64_tr_b16 v[36:37], v12 offset:10240
    ds_read_b64_tr_b16 v[38:39], v12 offset:11520
    s_add_u32 m0, s57, 0
    s_nop 0
    buffer_load_dwordx4 v16, s[16:19], s55 offen lds
    buffer_load_dwordx4 v17, s[16:19], s55 offen offset:1024 lds
    buffer_load_dwordx4 v[228:231], v13, s[4:7], s51 offen offset:0 sc1
    s_waitcnt lgkmcnt(0)
    v_mfma_f32_32x32x16_bf16 v[180:195], v[36:39], v[28:31], v[180:195]
    ds_read_b128 v[32:35], v11
    ds_read_b64_tr_b16 v[40:41], v12 offset:15360
    ds_read_b64_tr_b16 v[42:43], v12 offset:16640
    buffer_load_dwordx4 v18, s[16:19], s55 offen offset:2048 lds
    buffer_load_dwordx4 v19, s[16:19], s55 offen offset:3072 lds
    buffer_load_dwordx4 v[232:235], v13, s[4:7], s51 offen offset:512 sc1
    v_add_u32 v8, 36864, v8
    v_add_u32 v9, 36864, v9
    v_add_u32 v10, 36864, v10
    v_add_u32 v11, 36864, v11
    v_add_u32 v12, 36864, v12
    s_waitcnt lgkmcnt(0)
    v_mfma_f32_32x32x16_bf16 v[180:195], v[40:43], v[32:35], v[180:195]
    s_waitcnt vmcnt(18)
    s_barrier
    ds_read_b128 v[28:31], v8
    ds_read_b64_tr_b16 v[36:37], v12 offset:0
    ds_read_b64_tr_b16 v[38:39], v12 offset:1280
    s_add_u32 s60, s60, 1
    s_cmp_eq_u32 s60, 10
    s_cselect_b32 s60, 0, s60
    s_lshl_b32 s55, s60, 7
    s_mul_i32 s90, s60, s54
    s_add_u32 s90, s90, s95
    s_waitcnt lgkmcnt(0)
    v_mfma_f32_32x32x16_bf16 v[180:195], v[36:39], v[28:31], v[180:195]
    ds_read_b128 v[32:35], v9
    ds_read_b64_tr_b16 v[40:41], v12 offset:5120
    ds_read_b64_tr_b16 v[42:43], v12 offset:6400
    s_add_u32 m0, s91, 36864
    s_nop 0
    buffer_load_dwordx4 v58, s[8:11], s90 offen offset:2048 lds
    buffer_load_dwordx4 v59, s[8:11], s90 offen offset:3072 lds
    s_add_u32 m0, s91, 40960
    s_nop 0
    buffer_load_dwordx4 v60, s[8:11], s90 offen lds
    buffer_load_dwordx4 v[236:239], v13, s[4:7], s51 offen offset:1024 sc1
    s_waitcnt lgkmcnt(0)
    v_mfma_f32_32x32x16_bf16 v[180:195], v[40:43], v[32:35], v[180:195]
    ds_read_b128 v[28:31], v10
    ds_read_b64_tr_b16 v[36:37], v12 offset:10240
    ds_read_b64_tr_b16 v[38:39], v12 offset:11520
    s_add_u32 m0, s57, 36864
    s_nop 0
    buffer_load_dwordx4 v16, s[16:19], s55 offen lds
    buffer_load_dwordx4 v17, s[16:19], s55 offen offset:1024 lds
    buffer_load_dwordx4 v[240:243], v13, s[4:7], s51 offen offset:1536 sc1
    s_waitcnt lgkmcnt(0)
    v_mfma_f32_32x32x16_bf16 v[180:195], v[36:39], v[28:31], v[180:195]
    ds_read_b128 v[32:35], v11
    ds_read_b64_tr_b16 v[40:41], v12 offset:15360
    ds_read_b64_tr_b16 v[42:43], v12 offset:16640
    buffer_load_dwordx4 v18, s[16:19], s55 offen offset:2048 lds
    buffer_load_dwordx4 v19, s[16:19], s55 offen offset:3072 lds
    buffer_load_dwordx4 v[244:247], v13, s[4:7], s51 offen offset:2048 sc1
    v_add_u32 v8, 36864, v8
    v_add_u32 v9, 36864, v9
    v_add_u32 v10, 36864, v10
    v_add_u32 v11, 36864, v11
    v_add_u32 v12, 36864, v12
    s_waitcnt lgkmcnt(0)
    v_mfma_f32_32x32x16_bf16 v[180:195], v[40:43], v[32:35], v[180:195]
    s_waitcnt vmcnt(21)
    s_barrier
    ds_read_b128 v[28:31], v8
    ds_read_b64_tr_b16 v[36:37], v12 offset:0
    ds_read_b64_tr_b16 v[38:39], v12 offset:1280
    s_mov_b32 s8, s46
    s_mov_b32 s9, s47
    s_mov_b32 s10, 2211840
    s_mov_b32 s11, 0x00020000
    s_mul_i32 s90, s28, 552960
    s_mul_i32 s29, s87, 320
    s_add_u32 s90, s90, s29
    s_waitcnt lgkmcnt(0)
    v_mfma_f32_32x32x16_bf16 v[180:195], v[36:39], v[28:31], v[180:195]
    ds_read_b128 v[32:35], v9
    ds_read_b64_tr_b16 v[40:41], v12 offset:5120
    ds_read_b64_tr_b16 v[42:43], v12 offset:6400
    s_add_u32 m0, s91, 73728
    s_nop 0
    buffer_load_dwordx4 v200, s[8:11], s90 offen lds
    buffer_load_dwordx4 v201, s[8:11], s90 offen offset:1024 lds
    v_mul_u32_u24 v14, 384, v3
    v_lshl_add_u32 v14, v2, 4, v14
    v_add_u32 v14, 1024, v14
    v_mov_b32 v4, 0x80000000
    v_cmp_gt_u32 vcc, 21, v2
    v_min_u32 v15, 32, v1
    v_lshlrev_b32 v15, 3, v15
    v_cndmask_b32 v14, v4, v14, vcc
    v_add_u32 v15, 2560, v15
    s_waitcnt lgkmcnt(0)
    v_mfma_f32_32x32x16_bf16 v[180:195], v[40:43], v[32:35], v[180:195]
    ds_read_b128 v[28:31], v10
    ds_read_b64_tr_b16 v[36:37], v12 offset:10240
    ds_read_b64_tr_b16 v[38:39], v12 offset:11520
    buffer_load_dwordx4 v202, s[8:11], s90 offen offset:2048 lds
    buffer_load_dwordx4 v203, s[8:11], s90 offen offset:3072 lds
    s_waitcnt lgkmcnt(0)
    v_mfma_f32_32x32x16_bf16 v[180:195], v[36:39], v[28:31], v[180:195]
    ds_read_b128 v[32:35], v11
    ds_read_b64_tr_b16 v[40:41], v12 offset:15360
    ds_read_b64_tr_b16 v[42:43], v12 offset:16640
    s_add_u32 m0, s91, 77824
    s_nop 0
    buffer_load_dwordx4 v204, s[8:11], s90 offen lds
    s_mov_b32 s99, 262144
    s_waitcnt vmcnt(5)
    v_cmp_ne_u32 vcc, s53, v22
    s_cmp_eq_u32 vcc_hi, 0
    s_cselect_b32 s97, 1, 0
P1_FCGB:
    v_xor_b32 v5, s25, v207
    v_bitop3_b32 v5, v209, s25, v5 bitop3:0xbe
    v_bitop3_b32 v5, v229, s25, v5 bitop3:0xbe
    v_bitop3_b32 v5, v231, s25, v5 bitop3:0xbe
    v_bitop3_b32 v5, v233, s25, v5 bitop3:0xbe
    v_bitop3_b32 v5, v235, s25, v5 bitop3:0xbe
    v_bitop3_b32 v5, v237, s25, v5 bitop3:0xbe
    v_bitop3_b32 v5, v239, s25, v5 bitop3:0xbe
    v_bitop3_b32 v5, v241, s25, v5 bitop3:0xbe
    v_bitop3_b32 v5, v243, s25, v5 bitop3:0xbe
    v_bitop3_b32 v5, v245, s25, v5 bitop3:0xbe
    v_bitop3_b32 v5, v247, s25, v5 bitop3:0xbe
    v_cmp_ne_u32 vcc, 0, v5
    s_cbranch_vccz P1_FOKGB
    s_sleep 2
    s_sub_u32 s99, s99, 1
    s_cbranch_scc0 P1_GAGB
P1_FOKGB:
    v_add_u32 v8, -110592, v8
    v_add_u32 v9, -110592, v9
    v_add_u32 v10, -110592, v10
    v_add_u32 v11, -110592, v11
    v_add_u32 v12, -110592, v12
    s_waitcnt lgkmcnt(0)
    v_mfma_f32_32x32x16_bf16 v[180:195], v[40:43], v[32:35], v[180:195]
    s_waitcnt vmcnt(16)
    s_barrier
    ds_read_b128 v[28:31], v8
    ds_read_b64_tr_b16 v[36:37], v12 offset:0
    ds_read_b64_tr_b16 v[38:39], v12 offset:1280
    s_add_u32 s90, s90, 20480
    s_waitcnt lgkmcnt(0)
    v_mfma_f32_32x32x16_bf16 v[180:195], v[36:39], v[28:31], v[180:195]
    ds_read_b128 v[32:35], v9
    ds_read_b64_tr_b16 v[40:41], v12 offset:5120
    ds_read_b64_tr_b16 v[42:43], v12 offset:6400
    s_add_u32 m0, s91, 94208
    s_nop 0
    buffer_load_dwordx4 v200, s[8:11], s90 offen lds
    buffer_load_dwordx4 v201, s[8:11], s90 offen offset:1024 lds
    v_mov_b32 v44, v206
    v_mov_b32 v45, v206
    v_mul_f32 v46, s63, v208
    v_mul_f32 v47, s63, v208
    v_mov_b32 v206, s25
    v_mov_b32 v207, s97
    s_lshl_b32 s29, s28, 10
    s_add_u32 s29, s29, 149504
    v_lshl_add_u32 v4, v2, 5, s29
    ds_write_b128 v4, v[44:47]
    ds_write_b64 v4, v[206:207] offset:16
    v_add_f32 v228, v228, v232
    v_add_f32 v230, v230, v234
    v_add_f32 v228, v228, v236
    v_add_f32 v230, v230, v238
    v_add_f32 v228, v228, v240
    v_add_f32 v230, v230, v242
    v_add_f32 v228, v228, v244
    v_add_f32 v230, v230, v246
    s_waitcnt lgkmcnt(0)
    v_mfma_f32_32x32x16_bf16 v[180:195], v[40:43], v[32:35], v[180:195]
    ds_read_b128 v[28:31], v10
    ds_read_b64_tr_b16 v[36:37], v12 offset:10240
    ds_read_b64_tr_b16 v[38:39], v12 offset:11520
    buffer_load_dwordx4 v202, s[8:11], s90 offen offset:2048 lds
    buffer_load_dwordx4 v203, s[8:11], s90 offen offset:3072 lds
    v_and_b32 v4, 0xffff0000, v228
    v_sub_f32 v5, v228, v4
    v_lshrrev_b32 v52, 16, v228
    v_and_b32 v4, 0xffff0000, v5
    v_or_b32 v52, v52, v4
    v_sub_f32 v5, v5, v4
    v_lshrrev_b32 v53, 16, v5
    s_lshl_b32 s29, s28, 9
    s_add_u32 s29, s29, 147456
    v_lshl_add_u32 v4, v1, 3, s29
    ds_write_b64 v4, v[52:53]
    v_and_b32 v4, 0xffff0000, v230
    v_sub_f32 v5, v230, v4
    v_lshrrev_b32 v50, 16, v230
    v_and_b32 v4, 0xffff0000, v5
    v_or_b32 v50, v50, v4
    v_sub_f32 v5, v5, v4
    v_lshrrev_b32 v51, 16, v5
    s_waitcnt lgkmcnt(0)
    v_mfma_f32_32x32x16_bf16 v[180:195], v[36:39], v[28:31], v[180:195]
    ds_read_b128 v[32:35], v11
    ds_read_b64_tr_b16 v[40:41], v12 offset:15360
    ds_read_b64_tr_b16 v[42:43], v12 offset:16640
    s_add_u32 m0, s91, 98304
    s_nop 0
    buffer_load_dwordx4 v204, s[8:11], s90 offen lds
    v_add_u32 v8, 36864, v8
    v_add_u32 v9, 36864, v9
    v_add_u32 v10, 36864, v10
    v_add_u32 v11, 36864, v11
    v_add_u32 v12, 36864, v12
    s_waitcnt lgkmcnt(0)
    v_mfma_f32_32x32x16_bf16 v[180:195], v[40:43], v[32:35], v[180:195]
    s_waitcnt vmcnt(11)
    s_barrier
    ds_read_b128 v[28:31], v8
    ds_read_b64_tr_b16 v[36:37], v12 offset:0
    ds_read_b64_tr_b16 v[38:39], v12 offset:1280
    s_add_u32 s90, s90, 20480
    s_waitcnt lgkmcnt(0)
    v_mfma_f32_32x32x16_bf16 v[180:195], v[36:39], v[28:31], v[180:195]
    ds_read_b128 v[32:35], v9
    ds_read_b64_tr_b16 v[40:41], v12 offset:5120
    ds_read_b64_tr_b16 v[42:43], v12 offset:6400
    s_add_u32 m0, s91, 114688
    s_nop 0
    buffer_load_dwordx4 v200, s[8:11], s90 offen lds
    buffer_load_dwordx4 v201, s[8:11], s90 offen offset:1024 lds
    v_mfma_f32_32x32x8_bf16 v[180:195], v[50:51], v[44:45], v[180:195]
    buffer_load_dword v22, v23, s[4:7], 0 offen sc1
    s_waitcnt lgkmcnt(0)
    v_mfma_f32_32x32x16_bf16 v[180:195], v[40:43], v[32:35], v[180:195]
    ds_read_b128 v[28:31], v10
    ds_read_b64_tr_b16 v[36:37], v12 offset:10240
    ds_read_b64_tr_b16 v[38:39], v12 offset:11520
    buffer_load_dwordx4 v202, s[8:11], s90 offen offset:2048 lds
    buffer_load_dwordx4 v203, s[8:11], s90 offen offset:3072 lds
    s_waitcnt lgkmcnt(0)
    v_mfma_f32_32x32x16_bf16 v[180:195], v[36:39], v[28:31], v[180:195]
    ds_read_b128 v[32:35], v11
    ds_read_b64_tr_b16 v[40:41], v12 offset:15360
    ds_read_b64_tr_b16 v[42:43], v12 offset:16640
    s_add_u32 m0, s91, 118784
    s_nop 0
    buffer_load_dwordx4 v204, s[8:11], s90 offen lds
    s_waitcnt lgkmcnt(0)
    v_mfma_f32_32x32x16_bf16 v[180:195], v[40:43], v[32:35], v[180:195]
    s_barrier
    s_setprio 0
    s_nop 9
    v_pk_mul_f32 v[180:181], v[180:181], v[46:47]
    v_pk_mul_f32 v[182:183], v[182:183], v[46:47]
    v_pk_mul_f32 v[184:185], v[184:185], v[46:47]
    v_pk_mul_f32 v[186:187], v[186:187], v[46:47]
    v_pk_mul_f32 v[188:189], v[188:189], v[46:47]
    v_pk_mul_f32 v[190:191], v[190:191], v[46:47]
    v_pk_mul_f32 v[192:193], v[192:193], v[46:47]
    v_pk_mul_f32 v[194:195], v[194:195], v[46:47]
    v_cvt_pk_bf16_f32 v212, v180, v181
    v_cvt_pk_bf16_f32 v213, v182, v183
    v_cvt_pk_bf16_f32 v214, v184, v185
    v_cvt_pk_bf16_f32 v215, v186, v187
    v_cvt_pk_bf16_f32 v216, v188, v189
    v_cvt_pk_bf16_f32 v217, v190, v191
    v_cvt_pk_bf16_f32 v218, v192, v193
    v_cvt_pk_bf16_f32 v219, v194, v195
    s_cmp_lt_u32 s27, 4
    s_cbranch_scc1 NR_27
    v_pk_max_i16 v212, v212, 0
    v_pk_max_i16 v213, v213, 0
    v_pk_max_i16 v214, v214, 0
    v_pk_max_i16 v215, v215, 0
    v_pk_max_i16 v216, v216, 0
    v_pk_max_i16 v217, v217, 0
    v_pk_max_i16 v218, v218, 0
    v_pk_max_i16 v219, v219, 0
NR_27:
    s_add_u32 s29, s61, 8192
    s_cmp_eq_u32 s97, 0
    s_cbranch_scc1 SLOW_28
    buffer_store_dwordx4 v[212:215], v6, s[4:7], s29 offen offset:0
    buffer_store_dwordx4 v[216:219], v6, s[4:7], s29 offen offset:1024
STD_29:
    s_waitcnt vmcnt(5)
    v_cmp_ne_u32 vcc, s25, v22
    s_mov_b32 s89, 0
    s_cmp_lg_u32 vcc_lo, 0
    s_cbranch_scc1 NOKV_30
    s_mul_i32 s0, s28, 49152
    s_add_u32 s0, s0, 9830400
    buffer_load_dwordx4 v[228:231], v6, s[4:7], s0 offen sc1
    buffer_load_dwordx2 v[232:233], v15, s[4:7], s0 offen sc1
    buffer_load_dwordx4 v[234:237], v14, s[4:7], s0 offen sc1
    buffer_load_dwordx4 v[238:241], v14, s[4:7], s0 offen offset:768 sc1
    s_add_u32 s0, s0, 3072
    buffer_load_dwordx4 v[242:245], v6, s[4:7], s0 offen sc1
    buffer_load_dwordx2 v[246:247], v15, s[4:7], s0 offen sc1
    s_mov_b32 s89, 1
NOKV_30:
    v_mov_b64 v[248:249], 0
    v_mov_b64 v[250:251], 0
    v_mov_b64 v[252:253], 0
    v_mov_b64 v[254:255], 0
    v_mov_b64 v[176:177], 0
    v_mov_b64 v[178:179], 0
    v_mfma_f32_32x32x8_bf16 v[64:79], v[248:249], v[248:249], 0
    v_mfma_f32_32x32x8_bf16 v[80:95], v[248:249], v[248:249], 0
    v_mfma_f32_32x32x8_bf16 v[96:111], v[248:249], v[248:249], 0
    v_mfma_f32_32x32x8_bf16 v[112:127], v[248:249], v[248:249], 0
    v_mfma_f32_32x32x8_bf16 v[128:143], v[248:249], v[248:249], 0
    v_mfma_f32_32x32x8_bf16 v[144:159], v[248:249], v[248:249], 0
    v_mfma_f32_32x32x8_bf16 v[160:175], v[248:249], v[248:249], 0
    s_mul_i32 s31, s87, 10240
    s_add_u32 s31, s31, s92
    s_add_u32 s29, s28, 0
    s_and_b32 s29, s29, 3
    s_lshl_b32 s34, s29, 11
    s_add_u32 s34, s34, s31
    s_lshr_b32 s30, s29, 1
    s_lshl_b32 s30, s30, 10
    s_and_b32 s29, s29, 1
    s_lshl_b32 s29, s29, 3
    s_add_u32 s30, s30, s29
    s_add_u32 s30, s30, s31
    s_add_u32 s42, s30, 8192
    s_add_u32 s29, s28, 1
    s_and_b32 s29, s29, 3
    s_lshl_b32 s35, s29, 11
    s_add_u32 s35, s35, s31
    s_lshr_b32 s30, s29, 1
    s_lshl_b32 s30, s30, 10
    s_and_b32 s29, s29, 1
    s_lshl_b32 s29, s29, 3
    s_add_u32 s30, s30, s29
    s_add_u32 s30, s30, s31
    s_add_u32 s43, s30, 8192
    s_add_u32 s29, s28, 2
    s_and_b32 s29, s29, 3
    s_lshl_b32 s36, s29, 11
    s_add_u32 s36, s36, s31
    s_lshr_b32 s30, s29, 1
    s_lshl_b32 s30, s30, 10
    s_and_b32 s29, s29, 1
    s_lshl_b32 s29, s29, 3
    s_add_u32 s30, s30, s29
    s_add_u32 s30, s30, s31
    s_add_u32 s44, s30, 8192
    s_add_u32 s29, s28, 3
    s_and_b32 s29, s29, 3
    s_lshl_b32 s37, s29, 11
    s_add_u32 s37, s37, s31
    s_lshr_b32 s30, s29, 1
    s_lshl_b32 s30, s30, 10
    s_and_b32 s29, s29, 1
    s_lshl_b32 s29, s29, 3
    s_add_u32 s30, s30, s29
    s_add_u32 s30, s30, s31
    s_add_u32 s45, s30, 8192
    s_mul_i32 s31, s86, 40960
    s_add_u32 s31, s31, 10035200
    s_sub_u32 s31, s31, s92
    s_add_u32 s48, s34, s31
    s_add_u32 s49, s42, s31
    s_mov_b32 s1, 0
    s_lshr_b32 s29, s86, 2
    s_lshl_b32 s29, s29, 4
    s_add_u32 s29, s29, s87
    s_lshl_b32 s29, s29, 7
    s_add_u32 s88, s29, 13017120
    s_lshl_b32 s29, s24, 2
    s_add_u32 s29, s29, s62
    s_mov_b64 exec, 1
    s_waitcnt vmcnt(0)
    s_cmp_eq_u32 s97, 0
    s_cbranch_scc1 SLOW_31
    buffer_store_dword v21, v7, s[4:7], s29 offen offset:32
STD_32:
    s_mov_b64 exec, -1
    s_branch P2_ATT
P1_GAGB:
    s_lshl_b32 s29, s96, 9
    s_add_u32 s29, s29, 12656640
    v_lshlrev_b32 v4, 4, v2
    buffer_load_dwordx4 v[206:209], v4, s[4:7], s29 offen sc1
    v_mul_u32_u24 v5, 2560, v3
    v_add_u32 v13, v4, v5
    buffer_load_dwordx4 v[228:231], v13, s[4:7], s51 offen offset:0 sc1
    buffer_load_dwordx4 v[232:235], v13, s[4:7], s51 offen offset:512 sc1
    buffer_load_dwordx4 v[236:239], v13, s[4:7], s51 offen offset:1024 sc1
    buffer_load_dwordx4 v[240:243], v13, s[4:7], s51 offen offset:1536 sc1
    buffer_load_dwordx4 v[244:247], v13, s[4:7], s51 offen offset:2048 sc1
    s_waitcnt vmcnt(0)
    s_branch P1_FCGB
P1_KA0:
    v_lshlrev_b32 v56, 4, v1
    s_mul_i32 s95, s24, 640
    s_mov_b32 s54, 2560
    s_mul_i32 s90, s60, 2560
    s_add_u32 s90, s90, s95
    s_lshl_b32 s91, s24, 10
    s_waitcnt lgkmcnt(0)
    s_mov_b32 s8, s36
    s_mov_b32 s9, s37
    s_mov_b32 s10, 25600
    s_mov_b32 s11, 0x00020000
    s_mov_b32 s12, s38
    s_mov_b32 s13, s39
    s_mov_b32 s14, 25600
    s_mov_b32 s15, 0x00020000
    s_add_u32 m0, s91, 0
    s_nop 0
    buffer_load_dwordx4 v56, s[8:11], s90 offen lds
    s_add_u32 m0, s91, 4096
    s_nop 0
    buffer_load_dwordx4 v56, s[12:15], s90 offen lds
    s_barrier
    s_mov_b32 s16, s32
    s_mov_b32 s17, s33
    s_mov_b32 s18, 2621440
    s_mov_b32 s19, 0x00020000
    s_lshl_b32 s29, s26, 4
    s_add_u32 s29, s29, s27
    s_lshl_b32 s29, s29, 2
    s_add_u32 s56, s29, s28
    s_mul_i32 s29, s56, 2560
    v_mul_u32_u24 v4, 40, v1
    buffer_load_dwordx4 v[192:195], v4, s[16:19], s29 offen
    buffer_load_dwordx4 v[196:199], v4, s[16:19], s29 offen offset:16
    buffer_load_dwordx2 v[200:201], v4, s[16:19], s29 offen offset:32
    s_mov_b32 s4, s52
    s_mov_b32 s5, s53
    s_mov_b32 s6, 13083648
    s_mov_b32 s7, 0x00020000
    s_mov_b32 s20, s50
    s_mov_b32 s21, s51
    s_mov_b32 s22, 256
    s_mov_b32 s23, 0x00020000
    v_mov_b32 v7, 0
    v_mov_b64 v[52:53], 0
    v_mov_b64 v[54:55], 0
    v_and_b32 v2, 31, v1
    v_lshrrev_b32 v3, 5, v1
    v_mfma_f32_32x32x8_bf16 v[64:79], v[52:53], v[52:53], 0
    v_mfma_f32_32x32x8_bf16 v[160:175], v[52:53], v[52:53], 0
    v_mov_b32 v24, 0x3f803f80
    v_mov_b32 v25, 0x3f803f80
    v_bfe_u32 v4, v1, 1, 3
    v_xor_b32 v4, v4, v3
    s_lshl_b32 s29, s28, 12
    s_add_u32 s29, s29, 20480
    v_lshl_add_u32 v5, v2, 7, s29
    v_xor_b32 v6, 0, v4
    v_lshl_add_u32 v8, v6, 4, v5
    v_xor_b32 v6, 2, v4
    v_lshl_add_u32 v9, v6, 4, v5
    v_xor_b32 v6, 4, v4
    v_lshl_add_u32 v10, v6, 4, v5
    v_xor_b32 v6, 6, v4
    v_lshl_add_u32 v11, v6, 4, v5
    v_bfe_u32 v4, v1, 2, 2
    v_lshl_add_u32 v22, v3, 3, v4
    v_bfe_u32 v26, v1, 4, 1
    v_and_b32 v27, 3, v1
    v_lshl_add_u32 v4, v26, 2, v27
    v_min_u32 v4, 4, v4
    v_mul_u32_u24 v22, 40, v22
    v_lshl_add_u32 v16, v4, 3, v22
    s_add_u32 s60, s60, 1
    s_cmp_eq_u32 s60, 10
    s_cselect_b32 s60, 0, s60
    s_mul_i32 s90, s60, s54
    s_add_u32 s90, s90, s95
    s_add_u32 s91, s91, 36864
    s_add_u32 m0, s91, 0
    s_nop 0
    buffer_load_dwordx4 v56, s[8:11], s90 offen lds
    s_add_u32 m0, s91, 4096
    s_nop 0
    buffer_load_dwordx4 v56, s[12:15], s90 offen lds
    s_add_u32 s60, s60, 1
    s_cmp_eq_u32 s60, 10
    s_cselect_b32 s60, 0, s60
    s_mul_i32 s90, s60, s54
    s_add_u32 s90, s90, s95
    s_add_u32 s91, s91, 36864
    s_and_b32 s86, s2, 7
    s_lshl_b32 s86, s86, 3
    s_lshr_b32 s29, s2, 5
    s_add_u32 s86, s86, s29
    s_bfe_u32 s87, s2, 0x20003
    s_mul_i32 s92, s86, 153600
    s_mul_i32 s93, s86, 40960
    s_mul_i32 s29, s87, 320
    s_add_u32 s93, s93, s29
    s_lshl_b32 s94, s86, 2
    s_add_u32 s94, s94, s87
    s_lshl_b32 s94, s94, 7
    s_add_u32 s94, s94, 13049856
    s_mul_i32 s61, s96, 153600
    s_mul_i32 s29, s27, 10240
    s_add_u32 s61, s61, s29
    s_cmp_lt_u32 s27, 4
    s_cselect_b32 s63, 0x3ea52b5c, 1.0
    s_lshl_b32 s62, s26, 4
    s_add_u32 s62, s62, s27
    s_lshl_b32 s62, s62, 7
    s_add_u32 s62, s62, 13017088
    s_mov_b32 s97, 0
    s_mov_b32 s58, 0
    s_add_u32 m0, s91, 0
    s_nop 0
    buffer_load_dwordx4 v56, s[8:11], s90 offen lds
    s_add_u32 m0, s91, 4096
    s_nop 0
    buffer_load_dwordx4 v56, s[12:15], s90 offen lds
    s_add_u32 s60, s60, 1
    s_cmp_eq_u32 s60, 10
    s_cselect_b32 s60, 0, s60
    s_mul_i32 s90, s60, s54
    s_add_u32 s90, s90, s95
    s_add_u32 s91, s91, 36864
    s_waitcnt vmcnt(7)
    s_barrier
    ds_read_b128 v[28:31], v8
    ds_read_b64_tr_b16 v[128:129], v16 offset:0
    ds_read_b64_tr_b16 v[130:131], v16 offset:160
    ds_read_b128 v[32:35], v9
    ds_read_b64_tr_b16 v[132:133], v16 offset:1024
    ds_read_b64_tr_b16 v[134:135], v16 offset:1184
    ds_read_b128 v[36:39], v10
    ds_read_b64_tr_b16 v[136:137], v16 offset:2048
    ds_read_b64_tr_b16 v[138:139], v16 offset:2208
    ds_read_b128 v[40:43], v11
    ds_read_b64_tr_b16 v[140:141], v16 offset:3072
    ds_read_b64_tr_b16 v[142:143], v16 offset:3232
    buffer_load_dword v21, v7, s[20:23], 0 offen sc1
    s_add_u32 m0, s91, 0
    s_nop 0
    buffer_load_dwordx4 v56, s[8:11], s90 offen lds
    s_add_u32 m0, s91, 4096
    s_nop 0
    buffer_load_dwordx4 v56, s[12:15], s90 offen lds
P1_LKA:
    s_and_b32 s29, s58, 3
    s_mov_b32 s30, -110592
    s_cmov_b32 s30, 36864
    s_cmp_eq_u32 s29, 3
    s_mov_b32 s59, 36864
    s_cmov_b32 s59, -110592
    v_add_u32 v8, s59, v8
    v_add_u32 v9, s59, v9
    v_add_u32 v10, s59, v10
    v_add_u32 v11, s59, v11
    v_add_u32 v16, s59, v16
    s_add_u32 s60, s60, 1
    s_cmp_eq_u32 s60, 10
    s_cselect_b32 s60, 0, s60
    s_mul_i32 s90, s60, s54
    s_add_u32 s90, s90, s95
    s_add_u32 s91, s91, s30
    s_cmp_lg_u32 s58, 6
    s_cbranch_scc1 KS_33
    s_mov_b32 s10, 0
    s_mov_b32 s14, 0
KS_33:
    s_waitcnt vmcnt(4) lgkmcnt(0)
    s_barrier
    v_mfma_f32_32x32x16_bf16 v[64:79], v[128:131], v[28:31], v[64:79]
    ds_read_b128 v[80:83], v8
    ds_read_b64_tr_b16 v[144:145], v16 offset:0
    ds_read_b64_tr_b16 v[146:147], v16 offset:160
    v_mfma_f32_4x4x4_16b_bf16 v[160:163], v[24:25], v[128:129], v[160:163]
    v_mfma_f32_4x4x4_16b_bf16 v[164:167], v[24:25], v[130:131], v[164:167]
    s_add_u32 m0, s91, 0
    s_nop 0
    buffer_load_dwordx4 v56, s[8:11], s90 offen lds
    v_mfma_f32_32x32x16_bf16 v[64:79], v[132:135], v[32:35], v[64:79]
    ds_read_b128 v[84:87], v9
    ds_read_b64_tr_b16 v[148:149], v16 offset:1024
    ds_read_b64_tr_b16 v[150:151], v16 offset:1184
    v_mfma_f32_4x4x4_16b_bf16 v[160:163], v[24:25], v[132:133], v[160:163]
    v_mfma_f32_4x4x4_16b_bf16 v[164:167], v[24:25], v[134:135], v[164:167]
    s_add_u32 m0, s91, 4096
    s_nop 0
    buffer_load_dwordx4 v56, s[12:15], s90 offen lds
    v_mfma_f32_32x32x16_bf16 v[64:79], v[136:139], v[36:39], v[64:79]
    ds_read_b128 v[88:91], v10
    ds_read_b64_tr_b16 v[152:153], v16 offset:2048
    ds_read_b64_tr_b16 v[154:155], v16 offset:2208
    v_mfma_f32_4x4x4_16b_bf16 v[160:163], v[24:25], v[136:137], v[160:163]
    v_mfma_f32_4x4x4_16b_bf16 v[164:167], v[24:25], v[138:139], v[164:167]
    v_mfma_f32_32x32x16_bf16 v[64:79], v[140:143], v[40:43], v[64:79]
    ds_read_b128 v[92:95], v11
    ds_read_b64_tr_b16 v[156:157], v16 offset:3072
    ds_read_b64_tr_b16 v[158:159], v16 offset:3232
    v_mfma_f32_4x4x4_16b_bf16 v[160:163], v[24:25], v[140:141], v[160:163]
    v_mfma_f32_4x4x4_16b_bf16 v[164:167], v[24:25], v[142:143], v[164:167]
    s_add_u32 s58, s58, 1
    s_and_b32 s29, s58, 3
    s_mov_b32 s30, -110592
    s_cmov_b32 s30, 36864
    s_cmp_eq_u32 s29, 3
    s_mov_b32 s59, 36864
    s_cmov_b32 s59, -110592
    v_add_u32 v8, s59, v8
    v_add_u32 v9, s59, v9
    v_add_u32 v10, s59, v10
    v_add_u32 v11, s59, v11
    v_add_u32 v16, s59, v16
    s_add_u32 s60, s60, 1
    s_cmp_eq_u32 s60, 10
    s_cselect_b32 s60, 0, s60
    s_mul_i32 s90, s60, s54
    s_add_u32 s90, s90, s95
    s_add_u32 s91, s91, s30
    s_waitcnt vmcnt(4) lgkmcnt(0)
    s_barrier
    v_mfma_f32_32x32x16_bf16 v[64:79], v[144:147], v[80:83], v[64:79]
    ds_read_b128 v[28:31], v8
    ds_read_b64_tr_b16 v[128:129], v16 offset:0
    ds_read_b64_tr_b16 v[130:131], v16 offset:160
    v_mfma_f32_4x4x4_16b_bf16 v[160:163], v[24:25], v[144:145], v[160:163]
    v_mfma_f32_4x4x4_16b_bf16 v[164:167], v[24:25], v[146:147], v[164:167]
    s_add_u32 m0, s91, 0
    s_nop 0
    buffer_load_dwordx4 v56, s[8:11], s90 offen lds
    v_mfma_f32_32x32x16_bf16 v[64:79], v[148:151], v[84:87], v[64:79]
    ds_read_b128 v[32:35], v9
    ds_read_b64_tr_b16 v[132:133], v16 offset:1024
    ds_read_b64_tr_b16 v[134:135], v16 offset:1184
    v_mfma_f32_4x4x4_16b_bf16 v[160:163], v[24:25], v[148:149], v[160:163]
    v_mfma_f32_4x4x4_16b_bf16 v[164:167], v[24:25], v[150:151], v[164:167]
    s_add_u32 m0, s91, 4096
    s_nop 0
    buffer_load_dwordx4 v56, s[12:15], s90 offen lds
    v_mfma_f32_32x32x16_bf16 v[64:79], v[152:155], v[88:91], v[64:79]
    ds_read_b128 v[36:39], v10
    ds_read_b64_tr_b16 v[136:137], v16 offset:2048
    ds_read_b64_tr_b16 v[138:139], v16 offset:2208
    v_mfma_f32_4x4x4_16b_bf16 v[160:163], v[24:25], v[152:153], v[160:163]
    v_mfma_f32_4x4x4_16b_bf16 v[164:167], v[24:25], v[154:155], v[164:167]
    v_mfma_f32_32x32x16_bf16 v[64:79], v[156:159], v[92:95], v[64:79]
    ds_read_b128 v[40:43], v11
    ds_read_b64_tr_b16 v[140:141], v16 offset:3072
    ds_read_b64_tr_b16 v[142:143], v16 offset:3232
    v_mfma_f32_4x4x4_16b_bf16 v[160:163], v[24:25], v[156:157], v[160:163]
    v_mfma_f32_4x4x4_16b_bf16 v[164:167], v[24:25], v[158:159], v[164:167]
    s_cmp_lg_u32 s58, 1
    s_cbranch_scc1 KN_34
    s_mov_b32 s99, 262144
NON_36:
    v_readfirstlane_b32 s25, v21
    s_cmp_lg_u32 s25, 0
    s_cbranch_scc1 NOND_37
    buffer_load_dword v21, v7, s[20:23], 0 offen sc1
    s_waitcnt vmcnt(0)
    s_sub_u32 s99, s99, 1
    s_cbranch_scc0 NON_36
NOND_37:
    s_getreg_b32 s53, hwreg(HW_REG_XCC_ID, 0, 4)
    s_lshl_b32 s53, s53, 1
    s_xor_b32 s53, s53, s25
    s_cmp_lg_u32 s24, 0
    s_cbranch_scc1 XW_38
    s_and_b32 s29, s2, 7
    s_lshl_b32 s29, s29, 5
    s_lshr_b32 s30, s2, 3
    s_add_u32 s29, s29, s30
    s_lshl_b32 s29, s29, 2
    s_add_u32 s29, s29, 13082624
    v_mov_b32 v5, s53
    s_mov_b64 exec, 1
    buffer_store_dword v5, v7, s[4:7], s29 offen sc1
    s_mov_b64 exec, -1
XW_38:
    v_mov_b64 v[202:203], 0
    v_dot2c_f32_bf16 v202, v24, v192
    v_dot2c_f32_bf16 v203, v192, v192
    v_dot2c_f32_bf16 v202, v24, v193
    v_dot2c_f32_bf16 v203, v193, v193
    v_dot2c_f32_bf16 v202, v24, v194
    v_dot2c_f32_bf16 v203, v194, v194
    v_dot2c_f32_bf16 v202, v24, v195
    v_dot2c_f32_bf16 v203, v195, v195
    v_dot2c_f32_bf16 v202, v24, v196
    v_dot2c_f32_bf16 v203, v196, v196
    v_dot2c_f32_bf16 v202, v24, v197
    v_dot2c_f32_bf16 v203, v197, v197
    v_dot2c_f32_bf16 v202, v24, v198
    v_dot2c_f32_bf16 v203, v198, v198
    v_dot2c_f32_bf16 v202, v24, v199
    v_dot2c_f32_bf16 v203, v199, v199
    v_dot2c_f32_bf16 v202, v24, v200
    v_dot2c_f32_bf16 v203, v200, v200
    v_dot2c_f32_bf16 v202, v24, v201
    v_dot2c_f32_bf16 v203, v201, v201
    s_nop 2
    v_add_f32_dpp v202, v202, v202 row_shr:1 row_mask:0xf bank_mask:0xf bound_ctrl:0
    v_add_f32_dpp v203, v203, v203 row_shr:1 row_mask:0xf bank_mask:0xf bound_ctrl:0
    s_nop 0
    v_add_f32_dpp v202, v202, v202 row_shr:2 row_mask:0xf bank_mask:0xf bound_ctrl:0
    v_add_f32_dpp v203, v203, v203 row_shr:2 row_mask:0xf bank_mask:0xf bound_ctrl:0
    s_nop 0
    v_add_f32_dpp v202, v202, v202 row_shr:4 row_mask:0xf bank_mask:0xf bound_ctrl:0
    v_add_f32_dpp v203, v203, v203 row_shr:4 row_mask:0xf bank_mask:0xf bound_ctrl:0
    s_nop 0
    v_add_f32_dpp v202, v202, v202 row_shr:8 row_mask:0xf bank_mask:0xf bound_ctrl:0
    v_add_f32_dpp v203, v203, v203 row_shr:8 row_mask:0xf bank_mask:0xf bound_ctrl:0
    s_nop 0
    v_add_f32_dpp v202, v202, v202 row_bcast:15 row_mask:0xa bank_mask:0xf
    v_add_f32_dpp v203, v203, v203 row_bcast:15 row_mask:0xa bank_mask:0xf
    v_mul_f32 v202, 0x3acccccd, v202
    v_mul_f32 v203, 0x3acccccd, v203
    v_fma_f32 v203, -v202, v202, v203
    v_max_f32 v203, 0, v203
    v_cvt_pk_bf16_f32 v204, -v202, -v202
    v_cvt_pk_bf16_f32 v203, v203, v203
    v_and_b32 v203, 0xffff0000, v203
    v_add_f32 v203, 0x3727c5ac, v203
    v_cvt_pk_bf16_f32 v203, v203, v203
    v_and_b32 v203, 0xffff0000, v203
    v_sqrt_f32 v203, v203
    s_nop 0
    v_cvt_pk_bf16_f32 v203, v203, v203
    v_and_b32 v203, 0xffff0000, v203
    v_rcp_f32 v206, v203
    v_mov_b32 v205, v21
    v_mov_b32 v207, v21
    v_lshlrev_b32 v5, 4, v3
    s_lshl_b32 s29, s56, 5
    s_add_u32 s29, s29, 12656640
    s_mov_b32 exec_lo, 0x80000000
    s_mov_b32 exec_hi, 0x80000000
    buffer_store_dwordx4 v[204:207], v5, s[4:7], s29 offen sc1
    s_mov_b64 exec, -1
KN_34:
    s_cmp_lg_u32 s58, 7
    s_cbranch_scc1 KR_35
    s_lshl_b32 s29, s96, 9
    s_add_u32 s29, s29, 12656640
    v_lshlrev_b32 v4, 4, v2
    buffer_load_dwordx4 v[52:55], v4, s[4:7], s29 offen sc1
KR_35:
    s_add_u32 s58, s58, 1
    s_cmp_lt_u32 s58, 10
    s_cbranch_scc1 P1_LKA
    s_mov_b32 s99, 262144
    s_branch P1_GWKA
P1_GAKA:
    s_lshl_b32 s29, s96, 9
    s_add_u32 s29, s29, 12656640
    v_lshlrev_b32 v4, 4, v2
    buffer_load_dwordx4 v[52:55], v4, s[4:7], s29 offen sc1
P1_GWKA:
    s_waitcnt vmcnt(0) lgkmcnt(0)
    v_xor_b32 v5, s25, v53
    v_bitop3_b32 v5, v55, s25, v5 bitop3:0xbe
    v_cmp_ne_u32 vcc, 0, v5
    s_cbranch_vccz P1_FOKKA
    s_sleep 2
    s_sub_u32 s99, s99, 1
    s_cbranch_scc0 P1_GAKA
P1_FOKKA:
    v_add_f32 v160, v160, v164
    v_and_b32 v4, 0xffff0000, v160
    v_sub_f32 v5, v160, v4
    v_lshrrev_b32 v44, 16, v160
    v_and_b32 v4, 0xffff0000, v5
    v_or_b32 v44, v44, v4
    v_sub_f32 v5, v5, v4
    v_lshrrev_b32 v45, 16, v5
    v_mov_b32 v53, v52
    v_mov_b32 v55, v54
    v_lshlrev_b32 v6, 4, v1
    v_mfma_f32_32x32x8_bf16 v[64:79], v[44:45], v[52:53], v[64:79]
    s_nop 9
    s_mul_i32 s29, s96, 3072
    s_add_u32 s29, s29, 9830400
    v_pk_mul_f32 v[64:65], v[64:65], v[54:55]
    v_pk_mul_f32 v[66:67], v[66:67], v[54:55]
    v_pk_mul_f32 v[68:69], v[68:69], v[54:55]
    v_pk_mul_f32 v[70:71], v[70:71], v[54:55]
    v_pk_mul_f32 v[72:73], v[72:73], v[54:55]
    v_pk_mul_f32 v[74:75], v[74:75], v[54:55]
    v_cvt_pk_bf16_f32 v160, v64, v65
    v_cvt_pk_bf16_f32 v161, v66, v67
    v_cvt_pk_bf16_f32 v162, v68, v69
    v_cvt_pk_bf16_f32 v163, v70, v71
    v_cvt_pk_bf16_f32 v164, v72, v73
    v_cvt_pk_bf16_f32 v165, v74, v75
    v_min_u32 v4, 32, v1
    v_lshlrev_b32 v4, 3, v4
    s_mov_b32 exec_lo, 0
    v_mov_b32 v164, 0x3f803f80
    v_mov_b32 v165, 0x3f80
    s_mov_b32 exec_lo, -1
    buffer_store_dwordx4 v[160:163], v6, s[4:7], s29 offen sc1
    buffer_store_dwordx2 v[164:165], v4, s[4:7], s29 offen offset:2560 sc1
    s_waitcnt vmcnt(0) lgkmcnt(0)
    s_barrier
    s_movk_i32 s100, 960
    v_add_u32 v4, 0, v1
    v_mul_u32_u24 v5, 3277, v4
    v_lshrrev_b32 v5, 16, v5
    v_lshlrev_b32 v4, 4, v1
    v_mad_u32_u24 v232, v5, s100, v4
    v_add_u32 v4, 64, v1
    v_mul_u32_u24 v5, 3277, v4
    v_lshrrev_b32 v5, 16, v5
    v_lshlrev_b32 v4, 4, v1
    v_mad_u32_u24 v233, v5, s100, v4
    v_add_u32 v4, 128, v1
    v_mul_u32_u24 v5, 3277, v4
    v_lshrrev_b32 v5, 16, v5
    v_lshlrev_b32 v4, 4, v1
    v_mad_u32_u24 v234, v5, s100, v4
    v_add_u32 v4, 192, v1
    v_mul_u32_u24 v5, 3277, v4
    v_lshrrev_b32 v5, 16, v5
    v_lshlrev_b32 v4, 4, v1
    v_mad_u32_u24 v235, v5, s100, v4
    v_add_u32 v4, 256, v1
    v_mul_u32_u24 v5, 3277, v4
    v_lshrrev_b32 v5, 16, v5
    v_lshlrev_b32 v4, 4, v4
    v_mad_u32_u24 v236, v5, s100, v4
    s_barrier
    s_mov_b32 s16, s46
    s_mov_b32 s17, s47
    s_mov_b32 s18, 2211840
    s_mov_b32 s19, 0x00020000
    s_mul_i32 s31, s24, 5120
    s_mul_i32 s29, s24, 552960
    s_mul_i32 s30, s87, 320
    s_add_u32 s29, s29, s30
    s_add_u32 m0, s31, 73728
    s_nop 0
    buffer_load_dwordx4 v232, s[16:19], s29 offen lds
    buffer_load_dwordx4 v233, s[16:19], s29 offen offset:1024 lds
    buffer_load_dwordx4 v234, s[16:19], s29 offen offset:2048 lds
    buffer_load_dwordx4 v235, s[16:19], s29 offen offset:3072 lds
    s_add_u32 m0, s31, 77824
    s_nop 0
    buffer_load_dwordx4 v236, s[16:19], s29 offen lds
    s_add_u32 s29, s29, 20480
    s_add_u32 m0, s31, 94208
    s_nop 0
    buffer_load_dwordx4 v232, s[16:19], s29 offen lds
    buffer_load_dwordx4 v233, s[16:19], s29 offen offset:1024 lds
    buffer_load_dwordx4 v234, s[16:19], s29 offen offset:2048 lds
    buffer_load_dwordx4 v235, s[16:19], s29 offen offset:3072 lds
    s_add_u32 m0, s31, 98304
    s_nop 0
    buffer_load_dwordx4 v236, s[16:19], s29 offen lds
    s_add_u32 s29, s29, 20480
    s_add_u32 m0, s31, 114688
    s_nop 0
    buffer_load_dwordx4 v232, s[16:19], s29 offen lds
    buffer_load_dwordx4 v233, s[16:19], s29 offen offset:1024 lds
    buffer_load_dwordx4 v234, s[16:19], s29 offen offset:2048 lds
    buffer_load_dwordx4 v235, s[16:19], s29 offen offset:3072 lds
    s_add_u32 m0, s31, 118784
    s_nop 0
    buffer_load_dwordx4 v236, s[16:19], s29 offen lds
    s_add_u32 s29, s29, 20480
    s_branch P2_FFN
P1_KB:
    s_mov_b32 s4, s52
    s_mov_b32 s5, s53
    s_mov_b32 s6, 13083648
    s_mov_b32 s7, 0x00020000
    s_mov_b32 s20, s50
    s_mov_b32 s21, s51
    s_mov_b32 s22, 256
    s_mov_b32 s23, 0x00020000
    v_mov_b32 v7, 0
    v_mov_b64 v[52:53], 0
    v_mov_b64 v[54:55], 0
    v_and_b32 v2, 31, v1
    v_lshrrev_b32 v3, 5, v1
    v_mfma_f32_32x32x8_bf16 v[180:195], v[52:53], v[52:53], 0
    v_mfma_f32_32x32x8_bf16 v[212:227], v[52:53], v[52:53], 0
    v_mov_b32 v24, 0x3f803f80
    v_mov_b32 v25, 0x3f803f80
    v_bfe_u32 v4, v1, 1, 3
    v_xor_b32 v4, v4, v3
    s_lshl_b32 s29, s28, 12
    s_add_u32 s29, s29, 20480
    v_lshl_add_u32 v5, v2, 7, s29
    v_xor_b32 v6, 0, v4
    v_lshl_add_u32 v8, v6, 4, v5
    v_xor_b32 v6, 2, v4
    v_lshl_add_u32 v9, v6, 4, v5
    v_xor_b32 v6, 4, v4
    v_lshl_add_u32 v10, v6, 4, v5
    v_xor_b32 v6, 6, v4
    v_lshl_add_u32 v11, v6, 4, v5
    v_bfe_u32 v4, v1, 2, 2
    v_lshl_add_u32 v22, v3, 3, v4
    v_bfe_u32 v26, v1, 4, 1
    v_and_b32 v27, 3, v1
    v_lshl_add_u32 v4, v26, 2, v27
    v_min_u32 v4, 4, v4
    v_mul_u32_u24 v22, 40, v22
    v_lshl_add_u32 v12, v4, 3, v22
    v_add_u32 v12, 4096, v12
    s_add_u32 s60, s60, 1
    s_cmp_eq_u32 s60, 10
    s_cselect_b32 s60, 0, s60
    s_lshl_b32 s55, s60, 7
    s_add_u32 s57, s57, 36864
    s_add_u32 m0, s57, 0
    s_nop 0
    buffer_load_dwordx4 v16, s[16:19], s55 offen lds
    buffer_load_dwordx4 v17, s[16:19], s55 offen offset:1024 lds
    buffer_load_dwordx4 v18, s[16:19], s55 offen offset:2048 lds
    buffer_load_dwordx4 v19, s[16:19], s55 offen offset:3072 lds
    s_add_u32 s60, s60, 1
    s_cmp_eq_u32 s60, 10
    s_cselect_b32 s60, 0, s60
    s_lshl_b32 s55, s60, 7
    s_add_u32 s57, s57, 36864
    s_and_b32 s86, s2, 7
    s_lshl_b32 s86, s86, 3
    s_lshr_b32 s29, s2, 5
    s_add_u32 s86, s86, s29
    s_bfe_u32 s87, s2, 0x20003
    s_mul_i32 s92, s86, 153600
    s_mul_i32 s93, s86, 40960
    s_mul_i32 s29, s87, 320
    s_add_u32 s93, s93, s29
    s_lshl_b32 s94, s86, 2
    s_add_u32 s94, s94, s87
    s_lshl_b32 s94, s94, 7
    s_add_u32 s94, s94, 13049856
    s_mul_i32 s61, s96, 153600
    s_mul_i32 s29, s27, 10240
    s_add_u32 s61, s61, s29
    s_cmp_lt_u32 s27, 4
    s_cselect_b32 s63, 0x3ea52b5c, 1.0
    s_lshl_b32 s62, s26, 4
    s_add_u32 s62, s62, s27
    s_lshl_b32 s62, s62, 7
    s_add_u32 s62, s62, 13017088
    s_mov_b32 s97, 0
    s_mov_b32 s58, 0
    s_mov_b32 s12, s48
    s_mov_b32 s13, s49
    s_mov_b32 s14, 2621440
    s_mov_b32 s15, 0x00020000
    v_mov_b32 v4, 157696
    ds_write_b128 v4, v[52:55]
    s_add_u32 m0, s57, 0
    s_nop 0
    buffer_load_dwordx4 v16, s[16:19], s55 offen lds
    buffer_load_dwordx4 v17, s[16:19], s55 offen offset:1024 lds
    buffer_load_dwordx4 v18, s[16:19], s55 offen offset:2048 lds
    buffer_load_dwordx4 v19, s[16:19], s55 offen offset:3072 lds
    s_add_u32 s60, s60, 1
    s_cmp_eq_u32 s60, 10
    s_cselect_b32 s60, 0, s60
    s_lshl_b32 s55, s60, 7
    s_add_u32 s57, s57, 36864
    s_waitcnt vmcnt(8)
    s_barrier
    ds_read_b128 v[28:31], v8
    ds_read_b64_tr_b16 v[96:97], v12 offset:0
    ds_read_b64_tr_b16 v[98:99], v12 offset:160
    ds_read_b128 v[32:35], v9
    ds_read_b64_tr_b16 v[100:101], v12 offset:1024
    ds_read_b64_tr_b16 v[102:103], v12 offset:1184
    ds_read_b128 v[36:39], v10
    ds_read_b64_tr_b16 v[104:105], v12 offset:2048
    ds_read_b64_tr_b16 v[106:107], v12 offset:2208
    ds_read_b128 v[40:43], v11
    ds_read_b64_tr_b16 v[108:109], v12 offset:3072
    ds_read_b64_tr_b16 v[110:111], v12 offset:3232
    buffer_load_dword v21, v7, s[20:23], 0 offen sc1
    s_add_u32 m0, s57, 0
    s_nop 0
    buffer_load_dwordx4 v16, s[16:19], s55 offen lds
    buffer_load_dwordx4 v17, s[16:19], s55 offen offset:1024 lds
    buffer_load_dwordx4 v18, s[16:19], s55 offen offset:2048 lds
    buffer_load_dwordx4 v19, s[16:19], s55 offen offset:3072 lds
P1_LKB:
    s_and_b32 s29, s58, 3
    s_mov_b32 s30, -110592
    s_cmov_b32 s30, 36864
    s_cmp_eq_u32 s29, 3
    s_mov_b32 s59, 36864
    s_cmov_b32 s59, -110592
    v_add_u32 v8, s59, v8
    v_add_u32 v9, s59, v9
    v_add_u32 v10, s59, v10
    v_add_u32 v11, s59, v11
    v_add_u32 v12, s59, v12
    s_add_u32 s60, s60, 1
    s_cmp_eq_u32 s60, 10
    s_cselect_b32 s60, 0, s60
    s_lshl_b32 s55, s60, 7
    s_add_u32 s57, s57, s30
    s_cmp_lg_u32 s58, 6
    s_cbranch_scc1 KS_39
    s_mov_b32 s18, 0
KS_39:
    s_waitcnt vmcnt(8) lgkmcnt(0)
    s_barrier
    v_mfma_f32_32x32x16_bf16 v[180:195], v[96:99], v[28:31], v[180:195]
    ds_read_b128 v[196:199], v8
    ds_read_b64_tr_b16 v[112:113], v12 offset:0
    ds_read_b64_tr_b16 v[114:115], v12 offset:160
    v_mfma_f32_4x4x4_16b_bf16 v[212:215], v[24:25], v[96:97], v[212:215]
    v_mfma_f32_4x4x4_16b_bf16 v[216:219], v[24:25], v[98:99], v[216:219]
    s_add_u32 m0, s57, 0
    s_nop 0
    buffer_load_dwordx4 v16, s[16:19], s55 offen lds
    v_mfma_f32_32x32x16_bf16 v[180:195], v[100:103], v[32:35], v[180:195]
    ds_read_b128 v[200:203], v9
    ds_read_b64_tr_b16 v[116:117], v12 offset:1024
    ds_read_b64_tr_b16 v[118:119], v12 offset:1184
    v_mfma_f32_4x4x4_16b_bf16 v[212:215], v[24:25], v[100:101], v[212:215]
    v_mfma_f32_4x4x4_16b_bf16 v[216:219], v[24:25], v[102:103], v[216:219]
    buffer_load_dwordx4 v17, s[16:19], s55 offen offset:1024 lds
    v_mfma_f32_32x32x16_bf16 v[180:195], v[104:107], v[36:39], v[180:195]
    ds_read_b128 v[204:207], v10
    ds_read_b64_tr_b16 v[120:121], v12 offset:2048
    ds_read_b64_tr_b16 v[122:123], v12 offset:2208
    v_mfma_f32_4x4x4_16b_bf16 v[212:215], v[24:25], v[104:105], v[212:215]
    v_mfma_f32_4x4x4_16b_bf16 v[216:219], v[24:25], v[106:107], v[216:219]
    buffer_load_dwordx4 v18, s[16:19], s55 offen offset:2048 lds
    v_mfma_f32_32x32x16_bf16 v[180:195], v[108:111], v[40:43], v[180:195]
    ds_read_b128 v[208:211], v11
    ds_read_b64_tr_b16 v[124:125], v12 offset:3072
    ds_read_b64_tr_b16 v[126:127], v12 offset:3232
    v_mfma_f32_4x4x4_16b_bf16 v[212:215], v[24:25], v[108:109], v[212:215]
    v_mfma_f32_4x4x4_16b_bf16 v[216:219], v[24:25], v[110:111], v[216:219]
    buffer_load_dwordx4 v19, s[16:19], s55 offen offset:3072 lds
    s_add_u32 s58, s58, 1
    s_and_b32 s29, s58, 3
    s_mov_b32 s30, -110592
    s_cmov_b32 s30, 36864
    s_cmp_eq_u32 s29, 3
    s_mov_b32 s59, 36864
    s_cmov_b32 s59, -110592
    v_add_u32 v8, s59, v8
    v_add_u32 v9, s59, v9
    v_add_u32 v10, s59, v10
    v_add_u32 v11, s59, v11
    v_add_u32 v12, s59, v12
    s_add_u32 s60, s60, 1
    s_cmp_eq_u32 s60, 10
    s_cselect_b32 s60, 0, s60
    s_lshl_b32 s55, s60, 7
    s_add_u32 s57, s57, s30
    s_waitcnt vmcnt(8) lgkmcnt(0)
    s_barrier
    v_mfma_f32_32x32x16_bf16 v[180:195], v[112:115], v[196:199], v[180:195]
    ds_read_b128 v[28:31], v8
    ds_read_b64_tr_b16 v[96:97], v12 offset:0
    ds_read_b64_tr_b16 v[98:99], v12 offset:160
    v_mfma_f32_4x4x4_16b_bf16 v[212:215], v[24:25], v[112:113], v[212:215]
    v_mfma_f32_4x4x4_16b_bf16 v[216:219], v[24:25], v[114:115], v[216:219]
    s_add_u32 m0, s57, 0
    s_nop 0
    buffer_load_dwordx4 v16, s[16:19], s55 offen lds
    v_mfma_f32_32x32x16_bf16 v[180:195], v[116:119], v[200:203], v[180:195]
    ds_read_b128 v[32:35], v9
    ds_read_b64_tr_b16 v[100:101], v12 offset:1024
    ds_read_b64_tr_b16 v[102:103], v12 offset:1184
    v_mfma_f32_4x4x4_16b_bf16 v[212:215], v[24:25], v[116:117], v[212:215]
    v_mfma_f32_4x4x4_16b_bf16 v[216:219], v[24:25], v[118:119], v[216:219]
    buffer_load_dwordx4 v17, s[16:19], s55 offen offset:1024 lds
    v_mfma_f32_32x32x16_bf16 v[180:195], v[120:123], v[204:207], v[180:195]
    ds_read_b128 v[36:39], v10
    ds_read_b64_tr_b16 v[104:105], v12 offset:2048
    ds_read_b64_tr_b16 v[106:107], v12 offset:2208
    v_mfma_f32_4x4x4_16b_bf16 v[212:215], v[24:25], v[120:121], v[212:215]
    v_mfma_f32_4x4x4_16b_bf16 v[216:219], v[24:25], v[122:123], v[216:219]
    buffer_load_dwordx4 v18, s[16:19], s55 offen offset:2048 lds
    v_mfma_f32_32x32x16_bf16 v[180:195], v[124:127], v[208:211], v[180:195]
    ds_read_b128 v[40:43], v11
    ds_read_b64_tr_b16 v[108:109], v12 offset:3072
    ds_read_b64_tr_b16 v[110:111], v12 offset:3232
    v_mfma_f32_4x4x4_16b_bf16 v[212:215], v[24:25], v[124:125], v[212:215]
    v_mfma_f32_4x4x4_16b_bf16 v[216:219], v[24:25], v[126:127], v[216:219]
    buffer_load_dwordx4 v19, s[16:19], s55 offen offset:3072 lds
    s_cmp_lg_u32 s58, 1
    s_cbranch_scc1 KN_40
    s_mov_b32 s99, 262144
NON_42:
    v_readfirstlane_b32 s25, v21
    s_cmp_lg_u32 s25, 0
    s_cbranch_scc1 NOND_43
    buffer_load_dword v21, v7, s[20:23], 0 offen sc1
    s_waitcnt vmcnt(0)
    s_sub_u32 s99, s99, 1
    s_cbranch_scc0 NON_42
NOND_43:
    s_getreg_b32 s53, hwreg(HW_REG_XCC_ID, 0, 4)
    s_lshl_b32 s53, s53, 1
    s_xor_b32 s53, s53, s25
KN_40:
    s_cmp_lg_u32 s58, 7
    s_cbranch_scc1 KR_41
    s_lshl_b32 s29, s96, 9
    s_add_u32 s29, s29, 12656640
    v_lshlrev_b32 v4, 4, v2
    buffer_load_dwordx4 v[60:63], v4, s[4:7], s29 offen sc1
KR_41:
    s_add_u32 s58, s58, 1
    s_cmp_lt_u32 s58, 10
    s_cbranch_scc1 P1_LKB
    s_mov_b32 s99, 262144
    s_branch P1_GWKB
P1_GAKB:
    s_lshl_b32 s29, s96, 9
    s_add_u32 s29, s29, 12656640
    v_lshlrev_b32 v4, 4, v2
    buffer_load_dwordx4 v[60:63], v4, s[4:7], s29 offen sc1
P1_GWKB:
    s_waitcnt vmcnt(0) lgkmcnt(0)
    v_xor_b32 v5, s25, v61
    v_bitop3_b32 v5, v63, s25, v5 bitop3:0xbe
    v_cmp_ne_u32 vcc, 0, v5
    s_cbranch_vccz P1_FOKKB
    s_sleep 2
    s_sub_u32 s99, s99, 1
    s_cbranch_scc0 P1_GAKB
P1_FOKKB:
    v_add_f32 v212, v212, v216
    v_and_b32 v4, 0xffff0000, v212
    v_sub_f32 v5, v212, v4
    v_lshrrev_b32 v50, 16, v212
    v_and_b32 v4, 0xffff0000, v5
    v_or_b32 v50, v50, v4
    v_sub_f32 v5, v5, v4
    v_lshrrev_b32 v51, 16, v5
    v_mov_b32 v61, v60
    v_mov_b32 v63, v62
    v_lshlrev_b32 v6, 4, v1
    v_mfma_f32_32x32x8_bf16 v[180:195], v[50:51], v[60:61], v[180:195]
    s_nop 9
    s_mul_i32 s29, s96, 3072
    s_add_u32 s29, s29, 9830400
    v_pk_mul_f32 v[180:181], v[180:181], v[62:63]
    v_pk_mul_f32 v[182:183], v[182:183], v[62:63]
    v_pk_mul_f32 v[184:185], v[184:185], v[62:63]
    v_pk_mul_f32 v[186:187], v[186:187], v[62:63]
    v_pk_mul_f32 v[188:189], v[188:189], v[62:63]
    v_pk_mul_f32 v[190:191], v[190:191], v[62:63]
    s_mov_b32 exec_lo, 0
    v_mov_b32 v188, 1.0
    s_mov_b32 exec_lo, -1
    v_cvt_pk_bf16_f32 v212, v180, v181
    v_cvt_pk_bf16_f32 v213, v182, v183
    v_cvt_pk_bf16_f32 v214, v184, v185
    v_cvt_pk_bf16_f32 v215, v186, v187
    v_cvt_pk_bf16_f32 v216, v188, v189
    v_cvt_pk_bf16_f32 v217, v190, v191
    s_mul_i32 s30, s28, 1536
    s_add_u32 s30, s30, 147456
    v_lshrrev_b32 v4, 3, v2
    v_mul_u32_u24 v4, 384, v4
    v_and_b32 v5, 7, v2
    v_lshl_add_u32 v4, v5, 1, v4
    v_lshl_add_u32 v4, v3, 6, v4
    v_add_u32 v4, s30, v4
    ds_write_b16 v4, v212 offset:0
    ds_write_b16_d16_hi v4, v212 offset:16
    ds_write_b16 v4, v213 offset:32
    ds_write_b16_d16_hi v4, v213 offset:48
    ds_write_b16 v4, v214 offset:128
    ds_write_b16_d16_hi v4, v214 offset:144
    ds_write_b16 v4, v215 offset:160
    ds_write_b16_d16_hi v4, v215 offset:176
    ds_write_b16 v4, v216 offset:256
    ds_write_b16_d16_hi v4, v216 offset:272
    ds_write_b16 v4, v217 offset:288
    ds_write_b16_d16_hi v4, v217 offset:304
    v_add_u32 v4, s30, v6
    s_waitcnt lgkmcnt(0)
    ds_read_b128 v[220:223], v4
    ds_read_b128 v[224:227], v4 offset:1024
    s_waitcnt lgkmcnt(0)
    buffer_store_dwordx4 v[220:223], v6, s[4:7], s29 offen offset:1024 sc1
    s_mov_b32 exec_hi, 0
    buffer_store_dwordx4 v[224:227], v6, s[4:7], s29 offen offset:2048 sc1
    s_mov_b32 exec_hi, -1
    s_waitcnt vmcnt(0) lgkmcnt(0)
    s_barrier
    s_mov_b32 s89, 0
    s_cmp_lg_u32 s24, 4
    s_cbranch_scc1 P1_KNP
    s_mov_b64 exec, 1
    buffer_store_dword v21, v7, s[4:7], s62 offen sc1
    s_mov_b64 exec, -1
P1_KNP:
    s_mul_i32 s29, s87, 10240
    s_add_u32 s29, s29, s92
    s_mul_i32 s30, s28, 2560
    s_add_u32 s29, s29, s30
    v_lshlrev_b32 v4, 7, v1
    s_mov_b64 exec, 0xfffff
    buffer_load_dword v20, v4, s[4:7], s29 offen sc1
    s_mov_b64 exec, -1
    v_mul_u32_u24 v14, 384, v3
    v_lshl_add_u32 v14, v2, 4, v14
    v_add_u32 v14, 1024, v14
    v_mov_b32 v4, 0x80000000
    v_cmp_gt_u32 vcc, 21, v2
    v_min_u32 v15, 32, v1
    v_lshlrev_b32 v15, 3, v15
    v_cndmask_b32 v14, v4, v14, vcc
    v_add_u32 v15, 2560, v15
    v_and_b32 v4, 15, v1
    v_lshlrev_b32 v4, 11, v4
    v_add_u32 v4, 13019008, v4
    s_and_b32 s29, s2, 7
    s_lshl_b32 s29, s29, 7
    s_add_u32 s29, s29, 13082624
    v_cmp_gt_u32 vcc, 32, v1
    v_lshl_add_u32 v5, v2, 2, s29
    s_nop 0
    v_cndmask_b32 v23, v5, v4, vcc
    v_mov_b64 v[248:249], 0
    v_mov_b64 v[250:251], 0
    v_mov_b64 v[252:253], 0
    v_mov_b64 v[254:255], 0
    v_mov_b64 v[176:177], 0
    v_mov_b64 v[178:179], 0
    v_mfma_f32_32x32x8_bf16 v[64:79], v[248:249], v[248:249], 0
    v_mfma_f32_32x32x8_bf16 v[80:95], v[248:249], v[248:249], 0
    v_mfma_f32_32x32x8_bf16 v[96:111], v[248:249], v[248:249], 0
    v_mfma_f32_32x32x8_bf16 v[112:127], v[248:249], v[248:249], 0
    v_mfma_f32_32x32x8_bf16 v[128:143], v[248:249], v[248:249], 0
    v_mfma_f32_32x32x8_bf16 v[144:159], v[248:249], v[248:249], 0
    v_mfma_f32_32x32x8_bf16 v[160:175], v[248:249], v[248:249], 0
    s_mul_i32 s31, s87, 10240
    s_add_u32 s31, s31, s92
    s_add_u32 s29, s28, 0
    s_and_b32 s29, s29, 3
    s_lshl_b32 s34, s29, 11
    s_add_u32 s34, s34, s31
    s_lshr_b32 s30, s29, 1
    s_lshl_b32 s30, s30, 10
    s_and_b32 s29, s29, 1
    s_lshl_b32 s29, s29, 3
    s_add_u32 s30, s30, s29
    s_add_u32 s30, s30, s31
    s_add_u32 s42, s30, 8192
    s_add_u32 s29, s28, 1
    s_and_b32 s29, s29, 3
    s_lshl_b32 s35, s29, 11
    s_add_u32 s35, s35, s31
    s_lshr_b32 s30, s29, 1
    s_lshl_b32 s30, s30, 10
    s_and_b32 s29, s29, 1
    s_lshl_b32 s29, s29, 3
    s_add_u32 s30, s30, s29
    s_add_u32 s30, s30, s31
    s_add_u32 s43, s30, 8192
    s_add_u32 s29, s28, 2
    s_and_b32 s29, s29, 3
    s_lshl_b32 s36, s29, 11
    s_add_u32 s36, s36, s31
    s_lshr_b32 s30, s29, 1
    s_lshl_b32 s30, s30, 10
    s_and_b32 s29, s29, 1
    s_lshl_b32 s29, s29, 3
    s_add_u32 s30, s30, s29
    s_add_u32 s30, s30, s31
    s_add_u32 s44, s30, 8192
    s_add_u32 s29, s28, 3
    s_and_b32 s29, s29, 3
    s_lshl_b32 s37, s29, 11
    s_add_u32 s37, s37, s31
    s_lshr_b32 s30, s29, 1
    s_lshl_b32 s30, s30, 10
    s_and_b32 s29, s29, 1
    s_lshl_b32 s29, s29, 3
    s_add_u32 s30, s30, s29
    s_add_u32 s30, s30, s31
    s_add_u32 s45, s30, 8192
    s_mul_i32 s31, s86, 40960
    s_add_u32 s31, s31, 10035200
    s_sub_u32 s31, s31, s92
    s_add_u32 s48, s34, s31
    s_add_u32 s49, s42, s31
    s_mov_b32 s1, 0
    s_lshr_b32 s29, s86, 2
    s_lshl_b32 s29, s29, 4
    s_add_u32 s29, s29, s87
    s_lshl_b32 s29, s29, 7
    s_add_u32 s88, s29, 13017120
    s_waitcnt lgkmcnt(0)
    s_barrier
    s_branch P2_ATT
P2_ATT:
    s_setprio 3
    s_mov_b32 s8, 0
    v_lshlrev_b32 v2, 4, v1
    v_mov_b32 v5, 0x80000000
    v_cmp_gt_u32 vcc, 32, v1
    v_mov_b32 v4, 0xdddddddd
    v_mov_b32 v7, 157696
    v_cndmask_b32 v3, v5, v2, vcc
    v_mov_b32 v5, 1
    s_mov_b64 exec, 1
    ds_add_u32 v7, v5 offset:8
    s_mov_b64 exec, -1
    s_cmp_lg_u32 s89, 0
    s_cbranch_scc1 A_HAVEKV
    s_mov_b32 exec_hi, 0
    s_mov_b32 s99, 262144
POLL_44:
    buffer_load_dword v5, v23, s[4:7], 0 offen sc1
    s_waitcnt vmcnt(0)
    v_cmp_ne_u32 vcc, s25, v5
    s_cbranch_vccz POLLED_45
    s_sleep 1
    s_sub_u32 s99, s99, 1
    s_cbranch_scc0 POLL_44
POLLED_45:
    s_mov_b32 exec_hi, -1
A_RELOAD:
    s_mul_i32 s0, s28, 49152
    s_add_u32 s0, s0, 9830400
    buffer_load_dwordx4 v[228:231], v2, s[4:7], s0 offen sc1
    buffer_load_dwordx2 v[232:233], v15, s[4:7], s0 offen sc1
    buffer_load_dwordx4 v[234:237], v14, s[4:7], s0 offen sc1
    buffer_load_dwordx4 v[238:241], v14, s[4:7], s0 offen offset:768 sc1
    s_add_u32 s0, s0, 3072
    buffer_load_dwordx4 v[242:245], v2, s[4:7], s0 offen sc1
    buffer_load_dwordx2 v[246:247], v15, s[4:7], s0 offen sc1
A_HAVEKV:
    s_cmp_lg_u32 s97, 0
    s_cbranch_scc1 CF_46
    s_and_b32 s29, s2, 7
    s_lshl_b32 s29, s29, 7
    s_add_u32 s29, s29, 13082624
    v_and_b32 v6, 31, v1
    v_lshlrev_b32 v6, 2, v6
    buffer_load_dword v5, v6, s[4:7], s29 offen sc1
    s_waitcnt vmcnt(0)
    v_cmp_ne_u32 vcc, s53, v5
    s_cmp_eq_u64 vcc, 0
    s_cselect_b32 s97, 1, 0
CF_46:
    v_and_b32 v6, 31, v1
    s_add_u32 s29, s28, 0
    s_and_b32 s29, s29, 3
    s_mul_i32 s29, s29, 512
    s_add_u32 s29, s29, 155648
    v_lshl_add_u32 v8, v6, 3, s29
    s_add_u32 s29, s28, 1
    s_and_b32 s29, s29, 3
    s_mul_i32 s29, s29, 512
    s_add_u32 s29, s29, 155648
    v_lshl_add_u32 v9, v6, 3, s29
    s_add_u32 s29, s28, 2
    s_and_b32 s29, s29, 3
    s_mul_i32 s29, s29, 512
    s_add_u32 s29, s29, 155648
    v_lshl_add_u32 v10, v6, 3, s29
    s_add_u32 s29, s28, 3
    s_and_b32 s29, s29, 3
    s_mul_i32 s29, s29, 512
    s_add_u32 s29, s29, 155648
    v_lshl_add_u32 v11, v6, 3, s29
    s_and_b32 s29, s86, 2
    s_and_b32 s30, s86, 3
    s_add_u32 s30, s30, 4
    v_bfe_u32 v6, v1, 4, 1
    v_add_u32 v6, s29, v6
    s_mov_b32 exec_lo, 0
    v_mov_b32 v6, s30
    s_mov_b32 exec_lo, -1
    v_lshlrev_b32 v6, 2, v6
    s_mov_b32 s99, 262144
POLL_47:
    buffer_load_dword v5, v6, s[4:7], s88 offen sc1
    s_waitcnt vmcnt(0)
    v_cmp_ne_u32 vcc, s25, v5
    s_cbranch_vccz POLLED_48
    s_sleep 1
    s_sub_u32 s99, s99, 1
    s_cbranch_scc0 POLL_47
POLLED_48:
    s_cmp_lg_u32 s97, 0
    s_cbranch_scc1 CF_49
    s_and_b32 s29, s2, 7
    s_lshl_b32 s29, s29, 7
    s_add_u32 s29, s29, 13082624
    v_and_b32 v6, 31, v1
    v_lshlrev_b32 v6, 2, v6
    buffer_load_dword v5, v6, s[4:7], s29 offen sc1
    s_waitcnt vmcnt(0)
    v_cmp_ne_u32 vcc, s53, v5
    s_cmp_eq_u64 vcc, 0
    s_cselect_b32 s97, 1, 0
CF_49:
    buffer_load_dwordx4 v[180:183], v2, s[4:7], s34 offen sc1
    buffer_load_dwordx2 v[212:213], v3, s[4:7], s42 offen sc1
    buffer_load_dwordx4 v[184:187], v2, s[4:7], s34 offen offset:1024 sc1
    buffer_load_dwordx2 v[214:215], v3, s[4:7], s42 offen offset:512 sc1
    s_cmp_lg_u32 s8, 0
    s_cbranch_scc1 A_TRUEMAX
    buffer_load_dwordx4 v[188:191], v2, s[4:7], s35 offen sc1
    buffer_load_dwordx2 v[216:217], v3, s[4:7], s43 offen sc1
    buffer_load_dwordx4 v[192:195], v2, s[4:7], s35 offen offset:1024 sc1
    buffer_load_dwordx2 v[218:219], v3, s[4:7], s43 offen offset:512 sc1
    s_waitcnt vmcnt(4)
    v_mfma_f32_32x32x16_bf16 v[16:31], v[228:231], v[180:183], 0
    v_mfma_f32_32x32x8_bf16 v[16:31], v[232:233], v[212:213], v[16:31]
    v_mfma_f32_32x32x16_bf16 v[32:47], v[228:231], v[184:187], 0
    v_mfma_f32_32x32x8_bf16 v[32:47], v[232:233], v[214:215], v[32:47]
    buffer_load_dwordx4 v[196:199], v2, s[4:7], s36 offen sc1
    buffer_load_dwordx2 v[220:221], v3, s[4:7], s44 offen sc1
    buffer_load_dwordx4 v[200:203], v2, s[4:7], s36 offen offset:1024 sc1
    buffer_load_dwordx2 v[222:223], v3, s[4:7], s44 offen offset:512 sc1
    buffer_load_dwordx4 v[204:207], v2, s[4:7], s37 offen sc1
    buffer_load_dwordx2 v[224:225], v3, s[4:7], s45 offen sc1
    buffer_load_dwordx4 v[208:211], v2, s[4:7], s37 offen offset:1024 sc1
    buffer_load_dwordx2 v[226:227], v3, s[4:7], s45 offen offset:512 sc1
    s_nop 1
    v_max3_f32 v48, v16, v17, v18
    v_max3_f32 v48, v48, v19, v20
    v_max3_f32 v48, v48, v21, v22
    v_max3_f32 v48, v48, v23, v24
    v_max3_f32 v48, v48, v25, v26
    v_max3_f32 v48, v48, v27, v28
    v_max3_f32 v48, v48, v29, v30
    v_max_f32 v48, v48, v31
    v_max3_f32 v49, v32, v33, v34
    v_max3_f32 v49, v49, v35, v36
    v_max3_f32 v49, v49, v37, v38
    v_max3_f32 v49, v49, v39, v40
    v_max3_f32 v49, v49, v41, v42
    v_max3_f32 v49, v49, v43, v44
    v_max3_f32 v49, v49, v45, v46
    v_max_f32 v49, v49, v47
    v_mov_b32 v5, v48
    v_mov_b32 v6, v49
    s_nop 0
    v_permlane32_swap_b32 v5, v48
    v_permlane32_swap_b32 v6, v49
    v_max_f32 v48, v48, v5
    v_max_f32 v49, v49, v6
    s_mov_b32 exec_lo, 0
    v_cvt_pk_bf16_f32 v212, -v48, 0
    v_cvt_pk_bf16_f32 v214, -v49, 0
A_HAVEMAX:
    ds_write_b64 v8, v[212:213] offset:0
    ds_write_b64 v8, v[214:215] offset:256
    s_mov_b32 exec_lo, -1
    v_mov_b32 v5, 1
    s_mov_b64 exec, 1
    ds_add_u32 v7, v5
    s_mov_b64 exec, -1
    s_add_u32 s1, s1, 4
    s_mov_b32 s9, 8
    v_mfma_f32_32x32x16_bf16 v[16:31], v[228:231], v[180:183], 0
    v_mfma_f32_32x32x8_bf16 v[16:31], v[232:233], v[212:213], v[16:31]
    s_cmp_lg_u32 0, 0
    s_nop 10
.p2align 6
A_LOOP:
    v_mfma_f32_32x32x16_bf16 v[32:47], v[228:231], v[184:187], 0
    v_exp_f32 v16, v16
    v_exp_f32 v17, v17
    v_exp_f32 v18, v18
    v_smfmac_f32_32x32x32_bf16 v[164:179], v[248:251], v[64:71], v4
    v_exp_f32 v19, v19
    v_exp_f32 v20, v20
    v_exp_f32 v21, v21
    v_mfma_f32_32x32x8_bf16 v[32:47], v[232:233], v[214:215], v[32:47]
    v_exp_f32 v22, v22
    v_exp_f32 v23, v23
    v_exp_f32 v24, v24
    v_exp_f32 v25, v25
    v_smfmac_f32_32x32x32_bf16 v[164:179], v[252:255], v[72:79], v4
    v_exp_f32 v26, v26
    v_exp_f32 v27, v27
    v_exp_f32 v28, v28
    s_cbranch_scc0 A_FIRST
A_FIRSTD:
    s_waitcnt vmcnt(2)
    buffer_load_dwordx4 v[248:251], v14, s[4:7], s0 offen sc1
    v_exp_f32 v29, v29
    v_exp_f32 v30, v30
    v_exp_f32 v31, v31
    v_mfma_f32_32x32x16_bf16 v[48:63], v[228:231], v[188:191], 0
    v_exp_f32 v32, v32
    v_exp_f32 v33, v33
    v_exp_f32 v34, v34
    v_smfmac_f32_32x32x32_bf16 v[80:95], v[234:237], v[16:23], v4
    v_exp_f32 v35, v35
    v_exp_f32 v36, v36
    v_exp_f32 v37, v37
    v_mfma_f32_32x32x8_bf16 v[48:63], v[232:233], v[216:217], v[48:63]
    v_exp_f32 v38, v38
    v_exp_f32 v39, v39
    v_exp_f32 v40, v40
    v_exp_f32 v41, v41
    v_smfmac_f32_32x32x32_bf16 v[80:95], v[238:241], v[24:31], v4
    v_exp_f32 v42, v42
    v_exp_f32 v43, v43
    v_exp_f32 v44, v44
    buffer_load_dwordx4 v[252:255], v14, s[4:7], s0 offen offset:768 sc1
    v_exp_f32 v45, v45
    v_exp_f32 v46, v46
    v_exp_f32 v47, v47
    v_mfma_f32_32x32x16_bf16 v[64:79], v[228:231], v[192:195], 0
    v_exp_f32 v48, v48
    v_exp_f32 v49, v49
    v_exp_f32 v50, v50
    v_smfmac_f32_32x32x32_bf16 v[92:107], v[234:237], v[32:39], v4
    v_exp_f32 v51, v51
    v_exp_f32 v52, v52
    v_exp_f32 v53, v53
    v_mfma_f32_32x32x8_bf16 v[64:79], v[232:233], v[218:219], v[64:79]
    v_exp_f32 v54, v54
    v_exp_f32 v55, v55
    v_exp_f32 v56, v56
    v_exp_f32 v57, v57
    v_smfmac_f32_32x32x32_bf16 v[92:107], v[238:241], v[40:47], v4
    v_exp_f32 v58, v58
    v_exp_f32 v59, v59
    v_exp_f32 v60, v60
    s_add_u32 s0, s0, 3072
    v_exp_f32 v61, v61
    v_exp_f32 v62, v62
    v_exp_f32 v63, v63
    v_mfma_f32_32x32x16_bf16 v[16:31], v[228:231], v[196:199], 0
    v_exp_f32 v64, v64
    v_exp_f32 v65, v65
    v_exp_f32 v66, v66
    v_smfmac_f32_32x32x32_bf16 v[104:119], v[234:237], v[48:55], v4
    v_exp_f32 v67, v67
    v_exp_f32 v68, v68
    v_exp_f32 v69, v69
    v_mfma_f32_32x32x8_bf16 v[16:31], v[232:233], v[220:221], v[16:31]
    v_exp_f32 v70, v70
    v_exp_f32 v71, v71
    v_exp_f32 v72, v72
    v_exp_f32 v73, v73
    v_smfmac_f32_32x32x32_bf16 v[104:119], v[238:241], v[56:63], v4
    v_exp_f32 v74, v74
    v_exp_f32 v75, v75
    v_exp_f32 v76, v76
    s_sub_u32 s9, s9, 1
    v_exp_f32 v77, v77
    v_exp_f32 v78, v78
    v_exp_f32 v79, v79
    v_mfma_f32_32x32x16_bf16 v[32:47], v[228:231], v[200:203], 0
    v_exp_f32 v16, v16
    v_exp_f32 v17, v17
    v_exp_f32 v18, v18
    v_smfmac_f32_32x32x32_bf16 v[116:131], v[234:237], v[64:71], v4
    v_exp_f32 v19, v19
    v_exp_f32 v20, v20
    v_exp_f32 v21, v21
    v_mfma_f32_32x32x8_bf16 v[32:47], v[232:233], v[222:223], v[32:47]
    v_exp_f32 v22, v22
    v_exp_f32 v23, v23
    v_exp_f32 v24, v24
    v_exp_f32 v25, v25
    v_smfmac_f32_32x32x32_bf16 v[116:131], v[238:241], v[72:79], v4
    v_exp_f32 v26, v26
    v_exp_f32 v27, v27
    v_exp_f32 v28, v28
    s_cmp_eq_u32 s9, 0
    v_exp_f32 v29, v29
    v_exp_f32 v30, v30
    v_exp_f32 v31, v31
    v_mfma_f32_32x32x16_bf16 v[48:63], v[228:231], v[204:207], 0
    v_exp_f32 v32, v32
    v_exp_f32 v33, v33
    v_exp_f32 v34, v34
    v_smfmac_f32_32x32x32_bf16 v[128:143], v[234:237], v[16:23], v4
    v_exp_f32 v35, v35
    v_exp_f32 v36, v36
    v_exp_f32 v37, v37
    v_mfma_f32_32x32x8_bf16 v[48:63], v[232:233], v[224:225], v[48:63]
    v_exp_f32 v38, v38
    v_exp_f32 v39, v39
    v_exp_f32 v40, v40
    v_exp_f32 v41, v41
    v_smfmac_f32_32x32x32_bf16 v[128:143], v[238:241], v[24:31], v4
    v_exp_f32 v42, v42
    v_exp_f32 v43, v43
    v_exp_f32 v44, v44
    s_waitcnt vmcnt(2)
    v_exp_f32 v45, v45
    v_exp_f32 v46, v46
    v_exp_f32 v47, v47
    v_mfma_f32_32x32x16_bf16 v[64:79], v[228:231], v[208:211], 0
    v_exp_f32 v48, v48
    v_exp_f32 v49, v49
    v_exp_f32 v50, v50
    v_smfmac_f32_32x32x32_bf16 v[140:155], v[234:237], v[32:39], v4
    v_exp_f32 v51, v51
    v_exp_f32 v52, v52
    v_exp_f32 v53, v53
    v_mfma_f32_32x32x8_bf16 v[64:79], v[232:233], v[226:227], v[64:79]
    v_exp_f32 v54, v54
    v_exp_f32 v55, v55
    v_exp_f32 v56, v56
    v_exp_f32 v57, v57
    v_smfmac_f32_32x32x32_bf16 v[140:155], v[238:241], v[40:47], v4
    v_exp_f32 v58, v58
    v_exp_f32 v59, v59
    v_exp_f32 v60, v60
    buffer_load_dwordx4 v[228:231], v2, s[4:7], s0 offen sc1
    v_exp_f32 v61, v61
    v_exp_f32 v62, v62
    v_exp_f32 v63, v63
    v_mfma_f32_32x32x16_bf16 v[16:31], v[242:245], v[180:183], 0
    v_exp_f32 v64, v64
    v_exp_f32 v65, v65
    v_exp_f32 v66, v66
    v_smfmac_f32_32x32x32_bf16 v[152:167], v[234:237], v[48:55], v4
    v_exp_f32 v67, v67
    v_exp_f32 v68, v68
    v_exp_f32 v69, v69
    v_mfma_f32_32x32x8_bf16 v[16:31], v[246:247], v[212:213], v[16:31]
    v_exp_f32 v70, v70
    v_exp_f32 v71, v71
    v_exp_f32 v72, v72
    v_exp_f32 v73, v73
    v_smfmac_f32_32x32x32_bf16 v[152:167], v[238:241], v[56:63], v4
    v_exp_f32 v74, v74
    v_exp_f32 v75, v75
    v_exp_f32 v76, v76
    buffer_load_dwordx2 v[232:233], v15, s[4:7], s0 offen sc1
    v_exp_f32 v77, v77
    v_exp_f32 v78, v78
    v_exp_f32 v79, v79
    s_cbranch_scc1 A_LAST
    v_mfma_f32_32x32x16_bf16 v[32:47], v[242:245], v[184:187], 0
    v_exp_f32 v16, v16
    v_exp_f32 v17, v17
    v_exp_f32 v18, v18
    v_smfmac_f32_32x32x32_bf16 v[164:179], v[234:237], v[64:71], v4
    v_exp_f32 v19, v19
    v_exp_f32 v20, v20
    v_exp_f32 v21, v21
    v_mfma_f32_32x32x8_bf16 v[32:47], v[246:247], v[214:215], v[32:47]
    v_exp_f32 v22, v22
    v_exp_f32 v23, v23
    v_exp_f32 v24, v24
    v_exp_f32 v25, v25
    v_smfmac_f32_32x32x32_bf16 v[164:179], v[238:241], v[72:79], v4
    v_exp_f32 v26, v26
    v_exp_f32 v27, v27
    v_exp_f32 v28, v28
    s_waitcnt vmcnt(2)
    buffer_load_dwordx4 v[234:237], v14, s[4:7], s0 offen sc1
    v_exp_f32 v29, v29
    v_exp_f32 v30, v30
    v_exp_f32 v31, v31
    v_mfma_f32_32x32x16_bf16 v[48:63], v[242:245], v[188:191], 0
    v_exp_f32 v32, v32
    v_exp_f32 v33, v33
    v_exp_f32 v34, v34
    v_smfmac_f32_32x32x32_bf16 v[80:95], v[248:251], v[16:23], v4
    v_exp_f32 v35, v35
    v_exp_f32 v36, v36
    v_exp_f32 v37, v37
    v_mfma_f32_32x32x8_bf16 v[48:63], v[246:247], v[216:217], v[48:63]
    v_exp_f32 v38, v38
    v_exp_f32 v39, v39
    v_exp_f32 v40, v40
    v_exp_f32 v41, v41
    v_smfmac_f32_32x32x32_bf16 v[80:95], v[252:255], v[24:31], v4
    v_exp_f32 v42, v42
    v_exp_f32 v43, v43
    v_exp_f32 v44, v44
    buffer_load_dwordx4 v[238:241], v14, s[4:7], s0 offen offset:768 sc1
    v_exp_f32 v45, v45
    v_exp_f32 v46, v46
    v_exp_f32 v47, v47
    v_mfma_f32_32x32x16_bf16 v[64:79], v[242:245], v[192:195], 0
    v_exp_f32 v48, v48
    v_exp_f32 v49, v49
    v_exp_f32 v50, v50
    v_smfmac_f32_32x32x32_bf16 v[92:107], v[248:251], v[32:39], v4
    v_exp_f32 v51, v51
    v_exp_f32 v52, v52
    v_exp_f32 v53, v53
    v_mfma_f32_32x32x8_bf16 v[64:79], v[246:247], v[218:219], v[64:79]
    v_exp_f32 v54, v54
    v_exp_f32 v55, v55
    v_exp_f32 v56, v56
    v_exp_f32 v57, v57
    v_smfmac_f32_32x32x32_bf16 v[92:107], v[252:255], v[40:47], v4
    v_exp_f32 v58, v58
    v_exp_f32 v59, v59
    v_exp_f32 v60, v60
    s_add_u32 s0, s0, 3072
    v_exp_f32 v61, v61
    v_exp_f32 v62, v62
    v_exp_f32 v63, v63
    v_mfma_f32_32x32x16_bf16 v[16:31], v[242:245], v[196:199], 0
    v_exp_f32 v64, v64
    v_exp_f32 v65, v65
    v_exp_f32 v66, v66
    v_smfmac_f32_32x32x32_bf16 v[104:119], v[248:251], v[48:55], v4
    v_exp_f32 v67, v67
    v_exp_f32 v68, v68
    v_exp_f32 v69, v69
    v_mfma_f32_32x32x8_bf16 v[16:31], v[246:247], v[220:221], v[16:31]
    v_exp_f32 v70, v70
    v_exp_f32 v71, v71
    v_exp_f32 v72, v72
    v_exp_f32 v73, v73
    v_smfmac_f32_32x32x32_bf16 v[104:119], v[252:255], v[56:63], v4
    v_exp_f32 v74, v74
    v_exp_f32 v75, v75
    v_exp_f32 v76, v76
    v_exp_f32 v77, v77
    v_exp_f32 v78, v78
    v_exp_f32 v79, v79
    v_mfma_f32_32x32x16_bf16 v[32:47], v[242:245], v[200:203], 0
    v_exp_f32 v16, v16
    v_exp_f32 v17, v17
    v_exp_f32 v18, v18
    v_smfmac_f32_32x32x32_bf16 v[116:131], v[248:251], v[64:71], v4
    v_exp_f32 v19, v19
    v_exp_f32 v20, v20
    v_exp_f32 v21, v21
    v_mfma_f32_32x32x8_bf16 v[32:47], v[246:247], v[222:223], v[32:47]
    v_exp_f32 v22, v22
    v_exp_f32 v23, v23
    v_exp_f32 v24, v24
    v_exp_f32 v25, v25
    v_smfmac_f32_32x32x32_bf16 v[116:131], v[252:255], v[72:79], v4
    v_exp_f32 v26, v26
    v_exp_f32 v27, v27
    v_exp_f32 v28, v28
    s_cmp_eq_u32 0, 0
    v_exp_f32 v29, v29
    v_exp_f32 v30, v30
    v_exp_f32 v31, v31
    v_mfma_f32_32x32x16_bf16 v[48:63], v[242:245], v[204:207], 0
    v_exp_f32 v32, v32
    v_exp_f32 v33, v33
    v_exp_f32 v34, v34
    v_smfmac_f32_32x32x32_bf16 v[128:143], v[248:251], v[16:23], v4
    v_exp_f32 v35, v35
    v_exp_f32 v36, v36
    v_exp_f32 v37, v37
    v_mfma_f32_32x32x8_bf16 v[48:63], v[246:247], v[224:225], v[48:63]
    v_exp_f32 v38, v38
    v_exp_f32 v39, v39
    v_exp_f32 v40, v40
    v_exp_f32 v41, v41
    v_smfmac_f32_32x32x32_bf16 v[128:143], v[252:255], v[24:31], v4
    v_exp_f32 v42, v42
    v_exp_f32 v43, v43
    v_exp_f32 v44, v44
    s_waitcnt vmcnt(2)
    v_exp_f32 v45, v45
    v_exp_f32 v46, v46
    v_exp_f32 v47, v47
    v_mfma_f32_32x32x16_bf16 v[64:79], v[242:245], v[208:211], 0
    v_exp_f32 v48, v48
    v_exp_f32 v49, v49
    v_exp_f32 v50, v50
    v_smfmac_f32_32x32x32_bf16 v[140:155], v[248:251], v[32:39], v4
    v_exp_f32 v51, v51
    v_exp_f32 v52, v52
    v_exp_f32 v53, v53
    v_mfma_f32_32x32x8_bf16 v[64:79], v[246:247], v[226:227], v[64:79]
    v_exp_f32 v54, v54
    v_exp_f32 v55, v55
    v_exp_f32 v56, v56
    v_exp_f32 v57, v57
    v_smfmac_f32_32x32x32_bf16 v[140:155], v[252:255], v[40:47], v4
    v_exp_f32 v58, v58
    v_exp_f32 v59, v59
    v_exp_f32 v60, v60
    buffer_load_dwordx4 v[242:245], v2, s[4:7], s0 offen sc1
    v_exp_f32 v61, v61
    v_exp_f32 v62, v62
    v_exp_f32 v63, v63
    v_mfma_f32_32x32x16_bf16 v[16:31], v[228:231], v[180:183], 0
    v_exp_f32 v64, v64
    v_exp_f32 v65, v65
    v_exp_f32 v66, v66
    v_smfmac_f32_32x32x32_bf16 v[152:167], v[248:251], v[48:55], v4
    v_exp_f32 v67, v67
    v_exp_f32 v68, v68
    v_exp_f32 v69, v69
    v_mfma_f32_32x32x8_bf16 v[16:31], v[232:233], v[212:213], v[16:31]
    v_exp_f32 v70, v70
    v_exp_f32 v71, v71
    v_exp_f32 v72, v72
    v_exp_f32 v73, v73
    v_smfmac_f32_32x32x32_bf16 v[152:167], v[252:255], v[56:63], v4
    v_exp_f32 v74, v74
    v_exp_f32 v75, v75
    v_exp_f32 v76, v76
    buffer_load_dwordx2 v[246:247], v15, s[4:7], s0 offen sc1
    v_exp_f32 v77, v77
    v_exp_f32 v78, v78
    v_exp_f32 v79, v79
    s_branch A_LOOP
A_FIRST:
    s_mov_b32 s99, 4194304
    s_waitcnt vmcnt(0)
A_F0:
    ds_read_b32 v6, v7
    s_mov_b32 exec_lo, 0
    ds_read_b64 v[216:217], v9 offset:0
    ds_read_b64 v[218:219], v9 offset:256
    ds_read_b64 v[220:221], v10 offset:0
    ds_read_b64 v[222:223], v10 offset:256
    ds_read_b64 v[224:225], v11 offset:0
    ds_read_b64 v[226:227], v11 offset:256
    s_mov_b32 exec_lo, -1
    s_waitcnt lgkmcnt(6)
    v_readfirstlane_b32 s29, v6
    s_and_b32 s29, s29, 0xffff
    s_cmp_ge_u32 s29, s1
    s_cbranch_scc1 A_F0D
    s_sub_u32 s99, s99, 1
    s_cbranch_scc0 A_F0
A_F0D:
    v_and_b32 v5, 31, v1
    v_mul_u32_u24 v5, 288, v5
    v_sub_u32 v5, v2, v5
    v_add_u32 v5, 0xffaa8000, v5
    v_mad_u32_u24 v8, v8, 36, v5
    v_mad_u32_u24 v9, v9, 36, v5
    v_mad_u32_u24 v10, v10, 36, v5
    v_mad_u32_u24 v11, v11, 36, v5
    s_waitcnt lgkmcnt(0)
    s_branch A_FIRSTD
A_LAST:
    v_mfma_f32_32x32x16_bf16 v[32:47], v[242:245], v[188:191], 0
    v_exp_f32 v16, v16
    v_exp_f32 v17, v17
    v_exp_f32 v18, v18
    v_smfmac_f32_32x32x32_bf16 v[164:179], v[234:237], v[64:71], v4
    v_exp_f32 v19, v19
    v_exp_f32 v20, v20
    v_exp_f32 v21, v21
    v_mfma_f32_32x32x8_bf16 v[32:47], v[246:247], v[216:217], v[32:47]
    v_exp_f32 v22, v22
    v_exp_f32 v23, v23
    v_exp_f32 v24, v24
    v_exp_f32 v25, v25
    v_smfmac_f32_32x32x32_bf16 v[164:179], v[238:241], v[72:79], v4
    v_exp_f32 v26, v26
    v_exp_f32 v27, v27
    v_exp_f32 v28, v28
    s_waitcnt vmcnt(2)
    ds_read_b32 v5, v7
    v_exp_f32 v29, v29
    v_exp_f32 v30, v30
    v_exp_f32 v31, v31
    v_mfma_f32_32x32x16_bf16 v[48:63], v[242:245], v[196:199], 0
    v_exp_f32 v32, v32
    v_exp_f32 v33, v33
    v_exp_f32 v34, v34
    v_smfmac_f32_32x32x32_bf16 v[80:95], v[248:251], v[16:23], v4
    v_exp_f32 v35, v35
    v_exp_f32 v36, v36
    v_exp_f32 v37, v37
    v_mfma_f32_32x32x8_bf16 v[48:63], v[246:247], v[220:221], v[48:63]
    v_exp_f32 v38, v38
    v_exp_f32 v39, v39
    v_exp_f32 v40, v40
    v_exp_f32 v41, v41
    v_smfmac_f32_32x32x32_bf16 v[80:95], v[252:255], v[24:31], v4
    v_exp_f32 v42, v42
    v_exp_f32 v43, v43
    v_exp_f32 v44, v44
    s_waitcnt lgkmcnt(0)
    v_readfirstlane_b32 s29, v5
    v_exp_f32 v45, v45
    v_exp_f32 v46, v46
    v_exp_f32 v47, v47
    v_mfma_f32_32x32x16_bf16 v[64:79], v[242:245], v[204:207], 0
    v_exp_f32 v48, v48
    v_exp_f32 v49, v49
    v_exp_f32 v50, v50
    v_smfmac_f32_32x32x32_bf16 v[104:119], v[248:251], v[32:39], v4
    v_exp_f32 v51, v51
    v_exp_f32 v52, v52
    v_exp_f32 v53, v53
    v_mfma_f32_32x32x8_bf16 v[64:79], v[246:247], v[224:225], v[64:79]
    v_exp_f32 v54, v54
    v_exp_f32 v55, v55
    v_exp_f32 v56, v56
    v_exp_f32 v57, v57
    v_smfmac_f32_32x32x32_bf16 v[104:119], v[252:255], v[40:47], v4
    v_exp_f32 v58, v58
    v_exp_f32 v59, v59
    v_exp_f32 v60, v60
    s_cmp_lt_u32 s29, 8
    s_cbranch_scc1 A_OWAIT
A_OFREE:
    v_exp_f32 v61, v61
    v_exp_f32 v62, v62
    v_exp_f32 v63, v63
    v_mfma_f32_32x32x16_bf16 v[16:31], v[242:245], v[192:195], 0
    v_exp_f32 v64, v64
    v_exp_f32 v65, v65
    v_exp_f32 v66, v66
    v_smfmac_f32_32x32x32_bf16 v[128:143], v[248:251], v[48:55], v4
    v_exp_f32 v67, v67
    v_exp_f32 v68, v68
    v_exp_f32 v69, v69
    v_mfma_f32_32x32x8_bf16 v[16:31], v[246:247], v[218:219], v[16:31]
    ds_write_b128 v9, v[104:107] offset:0
    v_exp_f32 v70, v70
    v_exp_f32 v71, v71
    v_exp_f32 v72, v72
    v_exp_f32 v73, v73
    v_smfmac_f32_32x32x32_bf16 v[128:143], v[252:255], v[56:63], v4
    ds_write_b128 v9, v[108:111] offset:1024
    v_exp_f32 v74, v74
    v_exp_f32 v75, v75
    v_exp_f32 v76, v76
    ds_write_b128 v9, v[112:115] offset:2048
    v_exp_f32 v77, v77
    v_exp_f32 v78, v78
    v_exp_f32 v79, v79
    v_mfma_f32_32x32x16_bf16 v[32:47], v[242:245], v[200:203], 0
    v_exp_f32 v16, v16
    v_exp_f32 v17, v17
    v_exp_f32 v18, v18
    v_smfmac_f32_32x32x32_bf16 v[152:167], v[248:251], v[64:71], v4
    s_lshl_b32 s89, s8, 3
    s_add_u32 s89, s89, 4
    v_exp_f32 v19, v19
    v_exp_f32 v20, v20
    v_exp_f32 v21, v21
    v_mfma_f32_32x32x8_bf16 v[32:47], v[246:247], v[222:223], v[32:47]
    ds_write_b128 v10, v[128:131] offset:3072
    v_exp_f32 v22, v22
    v_exp_f32 v23, v23
    v_exp_f32 v24, v24
    v_exp_f32 v25, v25
    v_smfmac_f32_32x32x32_bf16 v[152:167], v[252:255], v[72:79], v4
    ds_write_b128 v10, v[132:135] offset:4096
    v_exp_f32 v26, v26
    v_exp_f32 v27, v27
    v_exp_f32 v28, v28
    ds_write_b128 v10, v[136:139] offset:5120
    v_exp_f32 v29, v29
    v_exp_f32 v30, v30
    v_exp_f32 v31, v31
    v_mfma_f32_32x32x16_bf16 v[48:63], v[242:245], v[208:211], 0
    v_exp_f32 v32, v32
    v_exp_f32 v33, v33
    v_exp_f32 v34, v34
    v_smfmac_f32_32x32x32_bf16 v[116:131], v[248:251], v[16:23], v4
    v_exp_f32 v35, v35
    v_exp_f32 v36, v36
    v_exp_f32 v37, v37
    v_mfma_f32_32x32x8_bf16 v[48:63], v[246:247], v[226:227], v[48:63]
    ds_write_b128 v11, v[152:155] offset:6144
    v_exp_f32 v38, v38
    v_exp_f32 v39, v39
    v_exp_f32 v40, v40
    v_exp_f32 v41, v41
    v_smfmac_f32_32x32x32_bf16 v[116:131], v[252:255], v[24:31], v4
    ds_write_b128 v11, v[156:159] offset:7168
    v_exp_f32 v42, v42
    v_exp_f32 v43, v43
    v_exp_f32 v44, v44
    ds_write_b128 v11, v[160:163] offset:8192
    v_mov_b32 v5, 1
    s_mov_b64 exec, 1
    ds_add_u32 v7, v5 offset:12
    s_mov_b64 exec, -1
    v_exp_f32 v45, v45
    v_exp_f32 v46, v46
    v_exp_f32 v47, v47
    v_mfma_f32_32x32x16_bf16 v[64:79], v[242:245], v[184:187], 0
    v_exp_f32 v48, v48
    v_exp_f32 v49, v49
    v_exp_f32 v50, v50
    v_smfmac_f32_32x32x32_bf16 v[140:155], v[248:251], v[32:39], v4
    v_exp_f32 v51, v51
    v_exp_f32 v52, v52
    v_exp_f32 v53, v53
    v_mfma_f32_32x32x8_bf16 v[64:79], v[246:247], v[214:215], v[64:79]
    ds_write_b128 v9, v[116:119] offset:9216
    v_exp_f32 v54, v54
    v_exp_f32 v55, v55
    v_exp_f32 v56, v56
    v_exp_f32 v57, v57
    v_smfmac_f32_32x32x32_bf16 v[140:155], v[252:255], v[40:47], v4
    ds_write_b128 v9, v[120:123] offset:10240
    v_exp_f32 v58, v58
    v_exp_f32 v59, v59
    v_exp_f32 v60, v60
    ds_write_b128 v9, v[124:127] offset:11264
    v_exp_f32 v61, v61
    v_exp_f32 v62, v62
    v_exp_f32 v63, v63
    v_exp_f32 v64, v64
    v_exp_f32 v65, v65
    v_exp_f32 v66, v66
    v_smfmac_f32_32x32x32_bf16 v[164:179], v[248:251], v[48:55], v4
    v_exp_f32 v67, v67
    v_exp_f32 v68, v68
    v_exp_f32 v69, v69
    ds_write_b128 v10, v[140:143] offset:12288
    v_exp_f32 v70, v70
    v_exp_f32 v71, v71
    v_exp_f32 v72, v72
    v_exp_f32 v73, v73
    v_smfmac_f32_32x32x32_bf16 v[164:179], v[252:255], v[56:63], v4
    ds_read_b32 v5, v7 offset:12
    ds_write_b128 v10, v[144:147] offset:13312
    v_exp_f32 v74, v74
    v_exp_f32 v75, v75
    v_exp_f32 v76, v76
    ds_write_b128 v10, v[148:151] offset:14336
    v_exp_f32 v77, v77
    v_exp_f32 v78, v78
    v_exp_f32 v79, v79
    s_nop 1
    v_smfmac_f32_32x32x32_bf16 v[92:107], v[248:251], v[64:71], v4
    v_smfmac_f32_32x32x32_bf16 v[92:107], v[252:255], v[72:79], v4
    s_mov_b64 s[38:39], 0
    s_mov_b32 s30, 0x71800000
    ds_write_b128 v11, v[164:167] offset:15360
    ds_write_b128 v11, v[168:171] offset:16384
    ds_write_b128 v11, v[172:175] offset:17408
    v_mov_b32 v13, 1
    s_mov_b64 exec, 1
    ds_add_u32 v7, v13
    s_mov_b64 exec, -1
    s_waitcnt lgkmcnt(6)
    v_readfirstlane_b32 s29, v5
    s_cmp_lt_u32 s29, s89
    s_cbranch_scc1 A_EWAIT
A_EOK:
    ds_read_b128 v[188:191], v8 offset:0
    ds_read_b128 v[192:195], v8 offset:1024
    ds_read_b128 v[196:199], v8 offset:2048
    ds_read_b128 v[200:203], v8 offset:3072
    ds_read_b128 v[204:207], v8 offset:4096
    ds_read_b128 v[208:211], v8 offset:5120
    ds_read_b128 v[216:219], v8 offset:6144
    ds_read_b128 v[220:223], v8 offset:7168
    ds_read_b128 v[224:227], v8 offset:8192
    s_add_u32 s1, s1, 4
    s_max_u32 s1, s1, 12
    s_waitcnt lgkmcnt(6)
    v_pk_add_f32 v[80:81], v[80:81], v[188:189]
    v_pk_add_f32 v[82:83], v[82:83], v[190:191]
    v_pk_add_f32 v[84:85], v[84:85], v[192:193]
    v_pk_add_f32 v[86:87], v[86:87], v[194:195]
    v_pk_add_f32 v[88:89], v[88:89], v[196:197]
    v_pk_add_f32 v[90:91], v[90:91], v[198:199]
    s_waitcnt lgkmcnt(3)
    v_pk_add_f32 v[80:81], v[80:81], v[200:201]
    v_pk_add_f32 v[82:83], v[82:83], v[202:203]
    v_pk_add_f32 v[84:85], v[84:85], v[204:205]
    v_pk_add_f32 v[86:87], v[86:87], v[206:207]
    v_pk_add_f32 v[88:89], v[88:89], v[208:209]
    v_pk_add_f32 v[90:91], v[90:91], v[210:211]
    s_waitcnt lgkmcnt(0)
    v_pk_add_f32 v[80:81], v[80:81], v[216:217]
    v_pk_add_f32 v[82:83], v[82:83], v[218:219]
    v_pk_add_f32 v[84:85], v[84:85], v[220:221]
    v_pk_add_f32 v[86:87], v[86:87], v[222:223]
    v_pk_add_f32 v[88:89], v[88:89], v[224:225]
    v_pk_add_f32 v[90:91], v[90:91], v[226:227]
    v_mov_b32 v5, v88
    v_mov_b32 v12, v88
    v_pk_mul_f32 v[52:53], v[80:81], 0 op_sel_hi:[1,0]
    v_pk_fma_f32 v[52:53], v[82:83], 0, v[52:53] op_sel_hi:[1,0,1]
    v_permlane32_swap_b32 v5, v12
    v_rcp_f32 v13, v12
    v_cmp_nlt_f32 vcc, v12, s30
    v_pk_fma_f32 v[52:53], v[84:85], 0, v[52:53] op_sel_hi:[1,0,1]
    v_pk_fma_f32 v[52:53], v[86:87], 0, v[52:53] op_sel_hi:[1,0,1]
    v_pk_fma_f32 v[52:53], v[88:89], 0, v[52:53] op_sel_hi:[1,0,1]
    v_pk_fma_f32 v[52:53], v[90:91], 0, v[52:53] op_sel_hi:[1,0,1]
    s_or_b64 s[38:39], s[38:39], vcc
    v_cmp_nlt_f32 vcc, 0x21800000, v12
    v_pk_mul_f32 v[80:81], v[80:81], v[12:13] op_sel:[0,1] op_sel_hi:[1,1]
    v_pk_mul_f32 v[82:83], v[82:83], v[12:13] op_sel:[0,1] op_sel_hi:[1,1]
    v_pk_mul_f32 v[84:85], v[84:85], v[12:13] op_sel:[0,1] op_sel_hi:[1,1]
    v_pk_mul_f32 v[86:87], v[86:87], v[12:13] op_sel:[0,1] op_sel_hi:[1,1]
    v_pk_mul_f32 v[88:89], v[88:89], v[12:13] op_sel:[0,1] op_sel_hi:[1,1]
    v_pk_mul_f32 v[90:91], v[90:91], v[12:13] op_sel:[0,1] op_sel_hi:[1,1]
    s_or_b64 s[38:39], s[38:39], vcc
    v_cmp_u_f32 vcc, v52, v53
    v_cvt_pk_bf16_f32 v128, v80, v81
    v_cvt_pk_bf16_f32 v129, v82, v83
    v_cvt_pk_bf16_f32 v130, v84, v85
    v_cvt_pk_bf16_f32 v131, v86, v87
    v_cvt_pk_bf16_f32 v132, v88, v89
    v_cvt_pk_bf16_f32 v133, v90, v91
    s_or_b64 s[38:39], s[38:39], vcc
    s_cmp_lg_u32 s8, 0
    s_cselect_b64 s[38:39], 0, s[38:39]
    v_min_u32 v128, -2, v128
    v_min_u32 v129, -2, v129
    v_min_u32 v130, -2, v130
    v_min_u32 v131, -2, v131
    v_min_u32 v132, -2, v132
    v_min_u32 v133, -2, v133
    s_cmp_lg_u64 s[38:39], 0
    s_cbranch_scc1 NOST_50
    s_cmp_eq_u32 s97, 0
    s_cbranch_scc1 SLOW_51
    buffer_store_dwordx4 v[128:131], v2, s[4:7], s48 offen offset:0
    buffer_store_dwordx2 v[132:133], v3, s[4:7], s49 offen offset:0
STD_52:
NOST_50:
    v_mov_b32 v5, 1
    s_mov_b64 exec, 1
    ds_add_u32 v7, v5 offset:12
    s_mov_b64 exec, -1
    s_mov_b32 s99, 4194304
CW_53:
    ds_read_b32 v5, v7
    s_waitcnt lgkmcnt(0)
    v_readfirstlane_b32 s29, v5
    s_and_b32 s31, s29, 0xffff
    s_cmp_ge_u32 s31, s1
    s_cbranch_scc1 CWD_54
    s_sub_u32 s99, s99, 1
    s_cbranch_scc0 CW_53
CWD_54:
    ds_read_b128 v[16:19], v8 offset:9216
    ds_read_b128 v[20:23], v8 offset:10240
    ds_read_b128 v[24:27], v8 offset:11264
    ds_read_b128 v[28:31], v8 offset:12288
    ds_read_b128 v[32:35], v8 offset:13312
    ds_read_b128 v[36:39], v8 offset:14336
    ds_read_b128 v[40:43], v8 offset:15360
    ds_read_b128 v[44:47], v8 offset:16384
    ds_read_b128 v[48:51], v8 offset:17408
    s_waitcnt lgkmcnt(6)
    v_pk_add_f32 v[92:93], v[92:93], v[16:17]
    v_pk_add_f32 v[94:95], v[94:95], v[18:19]
    v_pk_add_f32 v[96:97], v[96:97], v[20:21]
    v_pk_add_f32 v[98:99], v[98:99], v[22:23]
    v_pk_add_f32 v[100:101], v[100:101], v[24:25]
    v_pk_add_f32 v[102:103], v[102:103], v[26:27]
    s_waitcnt lgkmcnt(3)
    v_pk_add_f32 v[92:93], v[92:93], v[28:29]
    v_pk_add_f32 v[94:95], v[94:95], v[30:31]
    v_pk_add_f32 v[96:97], v[96:97], v[32:33]
    v_pk_add_f32 v[98:99], v[98:99], v[34:35]
    v_pk_add_f32 v[100:101], v[100:101], v[36:37]
    v_pk_add_f32 v[102:103], v[102:103], v[38:39]
    s_waitcnt lgkmcnt(0)
    v_pk_add_f32 v[92:93], v[92:93], v[40:41]
    v_pk_add_f32 v[94:95], v[94:95], v[42:43]
    v_pk_add_f32 v[96:97], v[96:97], v[44:45]
    v_pk_add_f32 v[98:99], v[98:99], v[46:47]
    v_pk_add_f32 v[100:101], v[100:101], v[48:49]
    v_pk_add_f32 v[102:103], v[102:103], v[50:51]
    v_mov_b32 v5, v100
    v_mov_b32 v12, v100
    v_pk_mul_f32 v[52:53], v[92:93], 0 op_sel_hi:[1,0]
    v_pk_fma_f32 v[52:53], v[94:95], 0, v[52:53] op_sel_hi:[1,0,1]
    v_permlane32_swap_b32 v5, v12
    v_rcp_f32 v13, v12
    v_cmp_nlt_f32 vcc, v12, s30
    v_pk_fma_f32 v[52:53], v[96:97], 0, v[52:53] op_sel_hi:[1,0,1]
    v_pk_fma_f32 v[52:53], v[98:99], 0, v[52:53] op_sel_hi:[1,0,1]
    v_pk_fma_f32 v[52:53], v[100:101], 0, v[52:53] op_sel_hi:[1,0,1]
    v_pk_fma_f32 v[52:53], v[102:103], 0, v[52:53] op_sel_hi:[1,0,1]
    s_or_b64 s[38:39], s[38:39], vcc
    v_cmp_nlt_f32 vcc, 0x21800000, v12
    v_pk_mul_f32 v[92:93], v[92:93], v[12:13] op_sel:[0,1] op_sel_hi:[1,1]
    v_pk_mul_f32 v[94:95], v[94:95], v[12:13] op_sel:[0,1] op_sel_hi:[1,1]
    v_pk_mul_f32 v[96:97], v[96:97], v[12:13] op_sel:[0,1] op_sel_hi:[1,1]
    v_pk_mul_f32 v[98:99], v[98:99], v[12:13] op_sel:[0,1] op_sel_hi:[1,1]
    v_pk_mul_f32 v[100:101], v[100:101], v[12:13] op_sel:[0,1] op_sel_hi:[1,1]
    v_pk_mul_f32 v[102:103], v[102:103], v[12:13] op_sel:[0,1] op_sel_hi:[1,1]
    s_or_b64 s[38:39], s[38:39], vcc
    v_cmp_u_f32 vcc, v52, v53
    v_cvt_pk_bf16_f32 v136, v92, v93
    v_cvt_pk_bf16_f32 v137, v94, v95
    v_cvt_pk_bf16_f32 v138, v96, v97
    v_cvt_pk_bf16_f32 v139, v98, v99
    v_cvt_pk_bf16_f32 v140, v100, v101
    v_cvt_pk_bf16_f32 v141, v102, v103
    s_or_b64 s[38:39], s[38:39], vcc
    s_cmp_lg_u32 s8, 0
    s_cselect_b64 s[38:39], 0, s[38:39]
    v_min_u32 v136, -2, v136
    v_min_u32 v137, -2, v137
    v_min_u32 v138, -2, v138
    v_min_u32 v139, -2, v139
    v_min_u32 v140, -2, v140
    v_min_u32 v141, -2, v141
    s_cmp_lg_u64 s[38:39], 0
    s_cbranch_scc1 NOST_55
    s_cmp_eq_u32 s97, 0
    s_cbranch_scc1 SLOW_56
    buffer_store_dwordx4 v[136:139], v2, s[4:7], s48 offen offset:1024
    buffer_store_dwordx2 v[140:141], v3, s[4:7], s49 offen offset:512
STD_57:
NOST_55:
    s_cmp_lg_u64 s[38:39], 0
    s_cselect_b32 s38, 0x10001, 1
    v_mov_b32 v5, s38
    s_mov_b64 exec, 1
    ds_add_u32 v7, v5
    s_mov_b64 exec, -1
    s_setprio 0
    s_add_u32 s1, s1, 4
    s_mov_b32 s16, s32
    s_mov_b32 s17, s33
    s_mov_b32 s18, 2621440
    s_mov_b32 s19, 0x00020000
    s_mov_b32 s99, 4194304
CW_58:
    ds_read_b32 v5, v7
    s_waitcnt lgkmcnt(0)
    v_readfirstlane_b32 s29, v5
    s_and_b32 s31, s29, 0xffff
    s_cmp_ge_u32 s31, s1
    s_cbranch_scc1 CWD_59
    s_sub_u32 s99, s99, 1
    s_cbranch_scc0 CW_58
CWD_59:
    s_lshr_b32 s29, s29, 16
    s_cmp_lg_u32 s8, 0
    s_cselect_b32 s29, 0, s29
    s_cmp_lg_u32 s29, 0
    s_cbranch_scc1 A_RESTART
    s_mov_b32 s100, 53248
    v_add_u32 v20, -256, v0
    v_lshrrev_b32 v16, 7, v20
    v_mul_u32_u24 v17, 20480, v16
    v_lshlrev_b32 v21, 6, v16
    v_and_b32 v16, 3, v20
    v_lshl_add_u32 v17, v16, 5, v17
    v_lshl_add_u32 v21, v16, 4, v21
    v_bfe_u32 v16, v20, 2, 5
    v_mul_u32_u24 v20, 144, v16
    v_mul_u32_u24 v16, 1280, v16
    v_add_u32 v21, v21, v16
    v_add3_u32 v20, v20, v17, s100
    buffer_load_dwordx4 v[16:19], v21, s[16:19], s93 offen
    s_mov_b32 s100, 53248
    v_add_u32 v22, 256, v0
    v_lshrrev_b32 v24, 7, v22
    v_mul_u32_u24 v25, 20480, v24
    v_lshlrev_b32 v23, 6, v24
    v_and_b32 v24, 3, v22
    v_lshl_add_u32 v25, v24, 5, v25
    v_lshl_add_u32 v23, v24, 4, v23
    v_bfe_u32 v24, v22, 2, 5
    v_mul_u32_u24 v22, 144, v24
    v_mul_u32_u24 v24, 1280, v24
    v_add_u32 v23, v23, v24
    v_add3_u32 v22, v22, v25, s100
    s_cmp_ge_u32 s24, 6
    s_cbranch_scc1 A_F1
    buffer_load_dwordx4 v[24:27], v23, s[16:19], s93 offen
A_F1:
    s_waitcnt vmcnt(0)
    v_lshlrev_b32 v64, 16, v16
    v_and_b32 v65, 0xffff0000, v16
    v_lshlrev_b32 v66, 16, v17
    v_and_b32 v67, 0xffff0000, v17
    v_lshlrev_b32 v68, 16, v18
    v_and_b32 v69, 0xffff0000, v18
    v_lshlrev_b32 v70, 16, v19
    v_and_b32 v71, 0xffff0000, v19
    v_lshlrev_b32 v112, 16, v24
    v_and_b32 v113, 0xffff0000, v24
    v_lshlrev_b32 v114, 16, v25
    v_and_b32 v115, 0xffff0000, v25
    v_lshlrev_b32 v116, 16, v26
    v_and_b32 v117, 0xffff0000, v26
    v_lshlrev_b32 v118, 16, v27
    v_and_b32 v119, 0xffff0000, v27
    s_barrier
    ds_read_b128 v[32:35], v20 offset:0
    ds_read_b128 v[36:39], v20 offset:16
    ds_read_b128 v[40:43], v20 offset:5120
    ds_read_b128 v[44:47], v20 offset:5136
    ds_read_b128 v[48:51], v20 offset:10240
    ds_read_b128 v[52:55], v20 offset:10256
    ds_read_b128 v[56:59], v20 offset:15360
    ds_read_b128 v[60:63], v20 offset:15376
    s_waitcnt lgkmcnt(6)
    v_pk_add_f32 v[64:65], v[64:65], v[32:33]
    v_pk_add_f32 v[66:67], v[66:67], v[34:35]
    v_pk_add_f32 v[68:69], v[68:69], v[36:37]
    v_pk_add_f32 v[70:71], v[70:71], v[38:39]
    s_waitcnt lgkmcnt(4)
    v_pk_add_f32 v[64:65], v[64:65], v[40:41]
    v_pk_add_f32 v[66:67], v[66:67], v[42:43]
    v_pk_add_f32 v[68:69], v[68:69], v[44:45]
    v_pk_add_f32 v[70:71], v[70:71], v[46:47]
    s_waitcnt lgkmcnt(2)
    v_pk_add_f32 v[64:65], v[64:65], v[48:49]
    v_pk_add_f32 v[66:67], v[66:67], v[50:51]
    v_pk_add_f32 v[68:69], v[68:69], v[52:53]
    v_pk_add_f32 v[70:71], v[70:71], v[54:55]
    s_waitcnt lgkmcnt(0)
    v_pk_add_f32 v[64:65], v[64:65], v[56:57]
    v_pk_add_f32 v[66:67], v[66:67], v[58:59]
    v_pk_add_f32 v[68:69], v[68:69], v[60:61]
    v_pk_add_f32 v[70:71], v[70:71], v[62:63]
    v_cvt_pk_bf16_f32 v16, v64, v65
    v_cvt_pk_bf16_f32 v17, v66, v67
    v_cvt_pk_bf16_f32 v18, v68, v69
    v_cvt_pk_bf16_f32 v19, v70, v71
    buffer_store_dwordx4 v[16:19], v21, s[12:15], s93 offen
    s_barrier
    s_cmp_ge_u32 s24, 6
    s_cbranch_scc1 A_F2
    ds_read_b128 v[80:83], v22 offset:0
    ds_read_b128 v[84:87], v22 offset:16
    ds_read_b128 v[88:91], v22 offset:5120
    ds_read_b128 v[92:95], v22 offset:5136
    ds_read_b128 v[96:99], v22 offset:10240
    ds_read_b128 v[100:103], v22 offset:10256
    ds_read_b128 v[104:107], v22 offset:15360
    ds_read_b128 v[108:111], v22 offset:15376
    s_waitcnt lgkmcnt(6)
    v_pk_add_f32 v[112:113], v[112:113], v[80:81]
    v_pk_add_f32 v[114:115], v[114:115], v[82:83]
    v_pk_add_f32 v[116:117], v[116:117], v[84:85]
    v_pk_add_f32 v[118:119], v[118:119], v[86:87]
    s_waitcnt lgkmcnt(4)
    v_pk_add_f32 v[112:113], v[112:113], v[88:89]
    v_pk_add_f32 v[114:115], v[114:115], v[90:91]
    v_pk_add_f32 v[116:117], v[116:117], v[92:93]
    v_pk_add_f32 v[118:119], v[118:119], v[94:95]
    s_waitcnt lgkmcnt(2)
    v_pk_add_f32 v[112:113], v[112:113], v[96:97]
    v_pk_add_f32 v[114:115], v[114:115], v[98:99]
    v_pk_add_f32 v[116:117], v[116:117], v[100:101]
    v_pk_add_f32 v[118:119], v[118:119], v[102:103]
    s_waitcnt lgkmcnt(0)
    v_pk_add_f32 v[112:113], v[112:113], v[104:105]
    v_pk_add_f32 v[114:115], v[114:115], v[106:107]
    v_pk_add_f32 v[116:117], v[116:117], v[108:109]
    v_pk_add_f32 v[118:119], v[118:119], v[110:111]
    v_cvt_pk_bf16_f32 v24, v112, v113
    v_cvt_pk_bf16_f32 v25, v114, v115
    v_cvt_pk_bf16_f32 v26, v116, v117
    v_cvt_pk_bf16_f32 v27, v118, v119
    buffer_store_dwordx4 v[24:27], v23, s[12:15], s93 offen
A_F2:
    s_endpgm
A_EWAIT:
    s_mov_b32 s99, 4194304
CW_60:
    ds_read_b32 v5, v7 offset:12
    s_waitcnt lgkmcnt(0)
    v_readfirstlane_b32 s29, v5
    s_and_b32 s31, s29, 0xffff
    s_cmp_ge_u32 s31, s89
    s_cbranch_scc1 CWD_61
    s_sub_u32 s99, s99, 1
    s_cbranch_scc0 CW_60
CWD_61:
    s_branch A_EOK
A_OWAIT:
    s_mov_b32 s99, 4194304
CW_62:
    ds_read_b32 v5, v7
    s_waitcnt lgkmcnt(0)
    v_readfirstlane_b32 s29, v5
    s_and_b32 s31, s29, 0xffff
    s_cmp_ge_u32 s31, 8
    s_cbranch_scc1 CWD_63
    s_sleep 1
    s_sub_u32 s99, s99, 1
    s_cbranch_scc0 CW_62
CWD_63:
    s_branch A_OFREE
A_RESTART:
    s_mov_b32 s8, 1
    s_waitcnt vmcnt(0)
    v_mov_b64 v[248:249], 0
    v_mov_b64 v[250:251], 0
    v_mov_b64 v[252:253], 0
    v_mov_b64 v[254:255], 0
    v_mov_b64 v[176:177], 0
    v_mov_b64 v[178:179], 0
    v_mfma_f32_32x32x8_bf16 v[64:79], v[248:249], v[248:249], 0
    v_mfma_f32_32x32x8_bf16 v[80:95], v[248:249], v[248:249], 0
    v_mfma_f32_32x32x8_bf16 v[96:111], v[248:249], v[248:249], 0
    v_mfma_f32_32x32x8_bf16 v[112:127], v[248:249], v[248:249], 0
    v_mfma_f32_32x32x8_bf16 v[128:143], v[248:249], v[248:249], 0
    v_mfma_f32_32x32x8_bf16 v[144:159], v[248:249], v[248:249], 0
    v_mfma_f32_32x32x8_bf16 v[160:175], v[248:249], v[248:249], 0
    s_branch A_RELOAD
A_TRUEMAX:
    buffer_load_dwordx4 v[188:191], v2, s[4:7], s35 offen sc1
    buffer_load_dwordx2 v[216:217], v3, s[4:7], s43 offen sc1
    buffer_load_dwordx4 v[192:195], v2, s[4:7], s35 offen offset:1024 sc1
    buffer_load_dwordx2 v[218:219], v3, s[4:7], s43 offen offset:512 sc1
    buffer_load_dwordx4 v[196:199], v2, s[4:7], s36 offen sc1
    buffer_load_dwordx2 v[220:221], v3, s[4:7], s44 offen sc1
    buffer_load_dwordx4 v[200:203], v2, s[4:7], s36 offen offset:1024 sc1
    buffer_load_dwordx2 v[222:223], v3, s[4:7], s44 offen offset:512 sc1
    buffer_load_dwordx4 v[204:207], v2, s[4:7], s37 offen sc1
    buffer_load_dwordx2 v[224:225], v3, s[4:7], s45 offen sc1
    buffer_load_dwordx4 v[208:211], v2, s[4:7], s37 offen offset:1024 sc1
    buffer_load_dwordx2 v[226:227], v3, s[4:7], s45 offen offset:512 sc1
    v_mov_b32 v48, 0xff800000
    v_mov_b32 v49, 0xff800000
    v_mov_b32 v50, 0xff800000
    v_mov_b32 v51, 0xff800000
    v_mov_b32 v52, 0xff800000
    v_mov_b32 v53, 0xff800000
    v_mov_b32 v54, 0xff800000
    v_mov_b32 v55, 0xff800000
    s_sub_u32 s30, s0, 3072
    s_mov_b32 s9, 16
A_TM_LOOP:
    buffer_load_dwordx4 v[32:35], v2, s[4:7], s30 offen sc1
    buffer_load_dwordx2 v[36:37], v15, s[4:7], s30 offen sc1
    s_waitcnt vmcnt(0)
    v_mfma_f32_32x32x16_bf16 v[16:31], v[32:35], v[180:183], 0
    v_mfma_f32_32x32x8_bf16 v[16:31], v[36:37], v[212:213], v[16:31]
    s_nop 11
    v_max3_f32 v48, v48, v16, v17
    v_max3_f32 v48, v48, v18, v19
    v_max3_f32 v48, v48, v20, v21
    v_max3_f32 v48, v48, v22, v23
    v_max3_f32 v48, v48, v24, v25
    v_max3_f32 v48, v48, v26, v27
    v_max3_f32 v48, v48, v28, v29
    v_max3_f32 v48, v48, v30, v31
    v_mfma_f32_32x32x16_bf16 v[16:31], v[32:35], v[184:187], 0
    v_mfma_f32_32x32x8_bf16 v[16:31], v[36:37], v[214:215], v[16:31]
    s_nop 11
    v_max3_f32 v49, v49, v16, v17
    v_max3_f32 v49, v49, v18, v19
    v_max3_f32 v49, v49, v20, v21
    v_max3_f32 v49, v49, v22, v23
    v_max3_f32 v49, v49, v24, v25
    v_max3_f32 v49, v49, v26, v27
    v_max3_f32 v49, v49, v28, v29
    v_max3_f32 v49, v49, v30, v31
    v_mfma_f32_32x32x16_bf16 v[16:31], v[32:35], v[188:191], 0
    v_mfma_f32_32x32x8_bf16 v[16:31], v[36:37], v[216:217], v[16:31]
    s_nop 11
    v_max3_f32 v50, v50, v16, v17
    v_max3_f32 v50, v50, v18, v19
    v_max3_f32 v50, v50, v20, v21
    v_max3_f32 v50, v50, v22, v23
    v_max3_f32 v50, v50, v24, v25
    v_max3_f32 v50, v50, v26, v27
    v_max3_f32 v50, v50, v28, v29
    v_max3_f32 v50, v50, v30, v31
    v_mfma_f32_32x32x16_bf16 v[16:31], v[32:35], v[192:195], 0
    v_mfma_f32_32x32x8_bf16 v[16:31], v[36:37], v[218:219], v[16:31]
    s_nop 11
    v_max3_f32 v51, v51, v16, v17
    v_max3_f32 v51, v51, v18, v19
    v_max3_f32 v51, v51, v20, v21
    v_max3_f32 v51, v51, v22, v23
    v_max3_f32 v51, v51, v24, v25
    v_max3_f32 v51, v51, v26, v27
    v_max3_f32 v51, v51, v28, v29
    v_max3_f32 v51, v51, v30, v31
    v_mfma_f32_32x32x16_bf16 v[16:31], v[32:35], v[196:199], 0
    v_mfma_f32_32x32x8_bf16 v[16:31], v[36:37], v[220:221], v[16:31]
    s_nop 11
    v_max3_f32 v52, v52, v16, v17
    v_max3_f32 v52, v52, v18, v19
    v_max3_f32 v52, v52, v20, v21
    v_max3_f32 v52, v52, v22, v23
    v_max3_f32 v52, v52, v24, v25
    v_max3_f32 v52, v52, v26, v27
    v_max3_f32 v52, v52, v28, v29
    v_max3_f32 v52, v52, v30, v31
    v_mfma_f32_32x32x16_bf16 v[16:31], v[32:35], v[200:203], 0
    v_mfma_f32_32x32x8_bf16 v[16:31], v[36:37], v[222:223], v[16:31]
    s_nop 11
    v_max3_f32 v53, v53, v16, v17
    v_max3_f32 v53, v53, v18, v19
    v_max3_f32 v53, v53, v20, v21
    v_max3_f32 v53, v53, v22, v23
    v_max3_f32 v53, v53, v24, v25
    v_max3_f32 v53, v53, v26, v27
    v_max3_f32 v53, v53, v28, v29
    v_max3_f32 v53, v53, v30, v31
    v_mfma_f32_32x32x16_bf16 v[16:31], v[32:35], v[204:207], 0
    v_mfma_f32_32x32x8_bf16 v[16:31], v[36:37], v[224:225], v[16:31]
    s_nop 11
    v_max3_f32 v54, v54, v16, v17
    v_max3_f32 v54, v54, v18, v19
    v_max3_f32 v54, v54, v20, v21
    v_max3_f32 v54, v54, v22, v23
    v_max3_f32 v54, v54, v24, v25
    v_max3_f32 v54, v54, v26, v27
    v_max3_f32 v54, v54, v28, v29
    v_max3_f32 v54, v54, v30, v31
    v_mfma_f32_32x32x16_bf16 v[16:31], v[32:35], v[208:211], 0
    v_mfma_f32_32x32x8_bf16 v[16:31], v[36:37], v[226:227], v[16:31]
    s_nop 11
    v_max3_f32 v55, v55, v16, v17
    v_max3_f32 v55, v55, v18, v19
    v_max3_f32 v55, v55, v20, v21
    v_max3_f32 v55, v55, v22, v23
    v_max3_f32 v55, v55, v24, v25
    v_max3_f32 v55, v55, v26, v27
    v_max3_f32 v55, v55, v28, v29
    v_max3_f32 v55, v55, v30, v31
    s_add_u32 s30, s30, 3072
    s_sub_u32 s9, s9, 1
    s_cmp_lg_u32 s9, 0
    s_cbranch_scc1 A_TM_LOOP
    v_mov_b32 v5, v48
    s_nop 1
    v_permlane32_swap_b32 v5, v48
    v_max_f32 v48, v48, v5
    v_add_u32 v6, -155648, v8
    ds_write_b32 v6, v48 offset:0
    v_mov_b32 v5, v49
    s_nop 1
    v_permlane32_swap_b32 v5, v49
    v_max_f32 v49, v49, v5
    v_add_u32 v6, -155648, v8
    ds_write_b32 v6, v49 offset:256
    v_mov_b32 v5, v50
    s_nop 1
    v_permlane32_swap_b32 v5, v50
    v_max_f32 v50, v50, v5
    v_add_u32 v6, -155648, v9
    ds_write_b32 v6, v50 offset:2048
    v_mov_b32 v5, v51
    s_nop 1
    v_permlane32_swap_b32 v5, v51
    v_max_f32 v51, v51, v5
    v_add_u32 v6, -155648, v9
    ds_write_b32 v6, v51 offset:2304
    v_mov_b32 v5, v52
    s_nop 1
    v_permlane32_swap_b32 v5, v52
    v_max_f32 v52, v52, v5
    v_add_u32 v6, -155648, v10
    ds_write_b32 v6, v52 offset:4096
    v_mov_b32 v5, v53
    s_nop 1
    v_permlane32_swap_b32 v5, v53
    v_max_f32 v53, v53, v5
    v_add_u32 v6, -155648, v10
    ds_write_b32 v6, v53 offset:4352
    v_mov_b32 v5, v54
    s_nop 1
    v_permlane32_swap_b32 v5, v54
    v_max_f32 v54, v54, v5
    v_add_u32 v6, -155648, v11
    ds_write_b32 v6, v54 offset:6144
    v_mov_b32 v5, v55
    s_nop 1
    v_permlane32_swap_b32 v5, v55
    v_max_f32 v55, v55, v5
    v_add_u32 v6, -155648, v11
    ds_write_b32 v6, v55 offset:6400
    v_mov_b32 v5, 1
    s_mov_b64 exec, 1
    ds_add_u32 v7, v5
    s_mov_b64 exec, -1
    s_add_u32 s1, s1, 4
    s_mov_b32 s99, 4194304
CW_64:
    ds_read_b32 v5, v7
    s_waitcnt lgkmcnt(0)
    v_readfirstlane_b32 s29, v5
    s_and_b32 s31, s29, 0xffff
    s_cmp_ge_u32 s31, s1
    s_cbranch_scc1 CWD_65
    s_sub_u32 s99, s99, 1
    s_cbranch_scc0 CW_64
CWD_65:
    v_add_u32 v6, -155648, v8
    ds_read_b32 v17, v6 offset:2048
    ds_read_b32 v18, v6 offset:4096
    ds_read_b32 v19, v6 offset:6144
    ds_read_b32 v21, v6 offset:2304
    ds_read_b32 v22, v6 offset:4352
    ds_read_b32 v23, v6 offset:6400
    s_waitcnt lgkmcnt(0)
    v_max3_f32 v48, v48, v17, v18
    v_max_f32 v48, v48, v19
    v_max3_f32 v49, v49, v21, v22
    v_max_f32 v49, v49, v23
    s_mov_b32 exec_lo, 0
    v_sub_f32 v48, 0, v48
    v_and_b32 v5, 0xffff0000, v48
    v_sub_f32 v6, v48, v5
    v_lshrrev_b32 v212, 16, v48
    v_and_b32 v5, 0xffff0000, v6
    v_or_b32 v212, v212, v5
    v_sub_f32 v6, v6, v5
    v_lshrrev_b32 v213, 16, v6
    v_sub_f32 v49, 0, v49
    v_and_b32 v5, 0xffff0000, v49
    v_sub_f32 v6, v49, v5
    v_lshrrev_b32 v214, 16, v49
    v_and_b32 v5, 0xffff0000, v6
    v_or_b32 v214, v214, v5
    v_sub_f32 v6, v6, v5
    v_lshrrev_b32 v215, 16, v6
    s_branch A_HAVEMAX
P2_FFN:
    s_movk_i32 s100, 960
    v_add_u32 v14, 0, v1
    v_mul_u32_u24 v15, 3277, v14
    v_lshrrev_b32 v15, 16, v15
    v_lshlrev_b32 v14, 4, v1
    v_mad_u32_u24 v232, v15, s100, v14
    v_add_u32 v14, 64, v1
    v_mul_u32_u24 v15, 3277, v14
    v_lshrrev_b32 v15, 16, v15
    v_lshlrev_b32 v14, 4, v1
    v_mad_u32_u24 v233, v15, s100, v14
    v_add_u32 v14, 128, v1
    v_mul_u32_u24 v15, 3277, v14
    v_lshrrev_b32 v15, 16, v15
    v_lshlrev_b32 v14, 4, v1
    v_mad_u32_u24 v234, v15, s100, v14
    v_add_u32 v14, 192, v1
    v_mul_u32_u24 v15, 3277, v14
    v_lshrrev_b32 v15, 16, v15
    v_lshlrev_b32 v14, 4, v1
    v_mad_u32_u24 v235, v15, s100, v14
    v_add_u32 v14, 256, v1
    v_mul_u32_u24 v15, 3277, v14
    v_lshrrev_b32 v15, 16, v15
    v_lshlrev_b32 v14, 4, v14
    v_mad_u32_u24 v236, v15, s100, v14
    v_add_u32 v14, 0, v1
    v_mul_u32_u24 v14, 3277, v14
    v_lshrrev_b32 v14, 18, v14
    v_mul_u32_u24 v14, 20480, v14
    v_add_u32 v237, v232, v14
    v_add_u32 v14, 64, v1
    v_mul_u32_u24 v14, 3277, v14
    v_lshrrev_b32 v14, 18, v14
    v_mul_u32_u24 v14, 20480, v14
    v_add_u32 v238, v233, v14
    v_add_u32 v14, 128, v1
    v_mul_u32_u24 v14, 3277, v14
    v_lshrrev_b32 v14, 18, v14
    v_mul_u32_u24 v14, 20480, v14
    v_add_u32 v239, v234, v14
    v_add_u32 v14, 192, v1
    v_mul_u32_u24 v14, 3277, v14
    v_lshrrev_b32 v14, 18, v14
    v_mul_u32_u24 v14, 20480, v14
    v_add_u32 v240, v235, v14
    v_add_u32 v14, 256, v1
    v_mul_u32_u24 v14, 3277, v14
    v_lshrrev_b32 v14, 18, v14
    v_mul_u32_u24 v14, 20480, v14
    v_add_u32 v241, v236, v14
    v_lshrrev_b32 v14, 5, v1
    v_bfe_u32 v15, v1, 2, 2
    v_lshl_add_u32 v14, v14, 2, v15
    v_mul_u32_u24 v244, 320, v14
    v_bfe_u32 v14, v1, 4, 1
    v_lshl_add_u32 v244, v14, 5, v244
    v_and_b32 v14, 3, v1
    v_lshl_add_u32 v244, v14, 3, v244
    s_mul_i32 s30, s28, 5120
    v_add_u32 v244, s30, v244
    v_add_u32 v252, 73728, v244
    v_mov_b64 v[248:249], -1
    v_mov_b64 v[250:251], -1
    s_mul_i32 s29, s28, 702
    s_lshr_b32 s29, s29, 8
    s_add_u32 s29, s29, 4
    v_add_u32 v242, s29, v14
    v_min_u32 v242, 14, v242
    s_lshr_b32 s31, s86, 2
    s_lshl_b32 s31, s31, 11
    s_add_u32 s31, s31, 13017120
    v_lshl_add_u32 v242, v242, 7, s31
    s_and_b32 s29, s86, 2
    s_and_b32 s30, s86, 3
    s_add_u32 s30, s30, 4
    v_bfe_u32 v15, v1, 4, 1
    v_add_u32 v15, s29, v15
    s_mov_b32 exec_lo, 0
    v_mov_b32 v15, s30
    s_mov_b32 exec_lo, -1
    v_lshlrev_b32 v15, 2, v15
    v_add_u32 v242, v242, v15
    s_lshl_b32 s31, s86, 2
    s_add_u32 s31, s31, s28
    s_lshl_b32 s31, s31, 7
    s_add_u32 s31, s31, 13049872
    v_lshl_add_u32 v243, v14, 2, s31
    s_mov_b32 s100, 53248
    v_add_u32 v253, 256, v0
    v_lshrrev_b32 v14, 7, v253
    v_mul_u32_u24 v15, 20480, v14
    v_lshlrev_b32 v254, 6, v14
    v_and_b32 v14, 3, v253
    v_lshl_add_u32 v15, v14, 5, v15
    v_lshl_add_u32 v254, v14, 4, v254
    v_bfe_u32 v14, v253, 2, 5
    v_mul_u32_u24 v253, 144, v14
    v_mul_u32_u24 v14, 1280, v14
    v_add_u32 v254, v254, v14
    v_add3_u32 v253, v253, v15, s100
    v_and_b32 v14, 31, v1
    v_mul_u32_u24 v14, 144, v14
    v_lshrrev_b32 v15, 5, v1
    v_lshl_add_u32 v14, v15, 4, v14
    s_mul_i32 s30, s28, 5120
    s_add_u32 s30, s30, 53248
    v_add_u32 v255, s30, v14
    s_mov_b32 s8, s46
    s_mov_b32 s9, s47
    s_mov_b32 s10, 2211840
    s_mov_b32 s11, 0x00020000
    s_mul_i32 s57, s28, 5120
    s_mul_i32 s54, s87, 320
    s_mul_i32 s55, s28, 552960
    s_add_u32 s55, s55, s54
    s_add_u32 s55, s55, 61440
    s_mov_b32 s56, 20480
    s_add_u32 m0, s57, 135168
    s_nop 0
    buffer_load_dwordx4 v232, s[8:11], s55 offen lds
    buffer_load_dwordx4 v233, s[8:11], s55 offen offset:1024 lds
    buffer_load_dwordx4 v234, s[8:11], s55 offen offset:2048 lds
    buffer_load_dwordx4 v235, s[8:11], s55 offen offset:3072 lds
    s_add_u32 m0, s57, 139264
    s_nop 0
    buffer_load_dwordx4 v236, s[8:11], s55 offen lds
    s_add_u32 s55, s55, s56
    v_mov_b64 v[246:247], 0
    v_lshlrev_b32 v2, 4, v1
    v_mov_b32 v13, 157696
    v_mfma_f32_32x32x8_bf16 v[16:31], v[246:247], v[246:247], 0
    v_mfma_f32_32x32x8_bf16 v[32:47], v[246:247], v[246:247], 0
    v_mfma_f32_32x32x8_bf16 v[48:63], v[246:247], v[246:247], 0
    v_mfma_f32_32x32x8_bf16 v[64:79], v[246:247], v[246:247], 0
    v_mfma_f32_32x32x8_bf16 v[80:95], v[246:247], v[246:247], 0
    v_mov_b32 v3, v252
    v_mov_b32 v4, v253
    v_mov_b32 v5, v254
    v_mov_b32 v0, v255
    v_add_u32 v6, 40960, v255
    v_mov_b32 v12, s25
    v_mov_b32 v245, 1
    s_mov_b32 s16, s32
    s_mov_b32 s17, s33
    s_mov_b32 s18, 2621440
    s_mov_b32 s19, 0x00020000
    s_mov_b32 s12, s48
    s_mov_b32 s13, s49
    s_mov_b32 s14, 2621440
    s_mov_b32 s15, 0x00020000
    s_mov_b32 s20, s40
    s_mov_b32 s21, s41
    s_mov_b32 s22, 819200
    s_mov_b32 s23, 0x00020000
    s_mul_i32 s95, s28, 204800
    s_add_u32 s95, s95, s54
    s_lshl_b32 s60, s86, 2
    s_add_u32 s60, s60, s28
    s_mul_i32 s59, s28, 27648
    s_add_u32 s59, s59, s92
    s_add_u32 s59, s59, 40960
    s_cmp_lg_u32 s97, 0
    s_cbranch_scc1 CF_66
    s_and_b32 s29, s2, 7
    s_lshl_b32 s29, s29, 7
    s_add_u32 s29, s29, 13082624
    v_and_b32 v15, 31, v1
    v_lshlrev_b32 v15, 2, v15
    buffer_load_dword v14, v15, s[4:7], s29 offen sc1
    s_waitcnt vmcnt(0)
    v_cmp_ne_u32 vcc, s53, v14
    s_cmp_eq_u64 vcc, 0
    s_cselect_b32 s97, 1, 0
CF_66:
    s_mov_b32 s99, 4194304
CW_67:
    ds_read_b32 v14, v13
    s_waitcnt lgkmcnt(0)
    v_readfirstlane_b32 s29, v14
    s_and_b32 s31, s29, 0xffff
    s_cmp_ge_u32 s31, 4
    s_cbranch_scc1 CWD_68
    s_sleep 1
    s_sub_u32 s99, s99, 1
    s_cbranch_scc0 CW_67
CWD_68:
    s_mov_b32 s99, 262144
POLL_69:
    buffer_load_dword v15, v242, s[4:7], 0 offen sc1
    s_waitcnt vmcnt(0)
    v_cmp_ne_u32 vcc, s25, v15
    s_cbranch_vccz POLLED_70
    s_sleep 2
    s_sub_u32 s99, s99, 1
    s_cbranch_scc0 POLL_69
POLLED_70:
    s_cmp_lg_u32 s97, 0
    s_cbranch_scc1 CF_71
    s_and_b32 s29, s2, 7
    s_lshl_b32 s29, s29, 7
    s_add_u32 s29, s29, 13082624
    v_and_b32 v15, 31, v1
    v_lshlrev_b32 v15, 2, v15
    buffer_load_dword v14, v15, s[4:7], s29 offen sc1
    s_waitcnt vmcnt(0)
    v_cmp_ne_u32 vcc, s53, v14
    s_cmp_eq_u64 vcc, 0
    s_cselect_b32 s97, 1, 0
CF_71:
    buffer_load_dwordx4 v[216:219], v2, s[4:7], s59 offen sc1
    s_add_u32 s59, s59, 1024
    buffer_load_dwordx4 v[220:223], v2, s[4:7], s59 offen sc1
    s_add_u32 s59, s59, 1024
    buffer_load_dwordx4 v[224:227], v2, s[4:7], s59 offen sc1
    s_add_u32 s59, s59, 1024
    buffer_load_dwordx4 v[228:231], v2, s[4:7], s59 offen sc1
    s_add_u32 s59, s59, 1024
    ds_read_b64_tr_b16 v[96:97], v3 offset:0
    ds_read_b64_tr_b16 v[98:99], v3 offset:2560
    ds_read_b64_tr_b16 v[100:101], v3 offset:64
    ds_read_b64_tr_b16 v[102:103], v3 offset:2624
    ds_read_b64_tr_b16 v[104:105], v3 offset:128
    ds_read_b64_tr_b16 v[106:107], v3 offset:2688
    ds_read_b64_tr_b16 v[108:109], v3 offset:192
    ds_read_b64_tr_b16 v[110:111], v3 offset:2752
    ds_read_b64_tr_b16 v[112:113], v3 offset:256
    ds_read_b64_tr_b16 v[114:115], v3 offset:2816
    s_mov_b32 s58, 0
    s_waitcnt vmcnt(0)
.p2align 3
F_LOOP:
    s_waitcnt vmcnt(13) lgkmcnt(0)
    v_mfma_f32_32x32x16_bf16 v[16:31], v[96:99], v[216:219], v[16:31]
    ds_read_b64_tr_b16 v[96:97], v3 offset:20480
    ds_read_b64_tr_b16 v[98:99], v3 offset:23040
    s_add_u32 m0, s57, 73728
    s_nop 0
    buffer_load_dwordx4 v232, s[8:11], s55 offen lds
    v_mfma_f32_32x32x16_bf16 v[32:47], v[100:103], v[216:219], v[32:47]
    ds_read_b64_tr_b16 v[100:101], v3 offset:20544
    ds_read_b64_tr_b16 v[102:103], v3 offset:23104
    buffer_load_dwordx4 v233, s[8:11], s55 offen offset:1024 lds
    v_mfma_f32_32x32x16_bf16 v[48:63], v[104:107], v[216:219], v[48:63]
    ds_read_b64_tr_b16 v[104:105], v3 offset:20608
    ds_read_b64_tr_b16 v[106:107], v3 offset:23168
    buffer_load_dwordx4 v234, s[8:11], s55 offen offset:2048 lds
    v_mfma_f32_32x32x16_bf16 v[64:79], v[108:111], v[216:219], v[64:79]
    ds_read_b64_tr_b16 v[108:109], v3 offset:20672
    ds_read_b64_tr_b16 v[110:111], v3 offset:23232
    buffer_load_dwordx4 v235, s[8:11], s55 offen offset:3072 lds
    v_mfma_f32_32x32x16_bf16 v[80:95], v[112:115], v[216:219], v[80:95]
    ds_read_b64_tr_b16 v[112:113], v3 offset:20736
    ds_read_b64_tr_b16 v[114:115], v3 offset:23296
    s_add_u32 m0, s57, 77824
    s_nop 0
    buffer_load_dwordx4 v236, s[8:11], s55 offen lds
    s_add_u32 s55, s55, s56
    buffer_load_dwordx4 v[216:219], v2, s[4:7], s59 offen sc1
    s_add_u32 s59, s59, 1024
    s_waitcnt vmcnt(13) lgkmcnt(0)
    v_mfma_f32_32x32x16_bf16 v[16:31], v[96:99], v[220:223], v[16:31]
    ds_read_b64_tr_b16 v[96:97], v3 offset:40960
    ds_read_b64_tr_b16 v[98:99], v3 offset:43520
    s_add_u32 m0, s57, 94208
    s_nop 0
    buffer_load_dwordx4 v232, s[8:11], s55 offen lds
    v_mfma_f32_32x32x16_bf16 v[32:47], v[100:103], v[220:223], v[32:47]
    ds_read_b64_tr_b16 v[100:101], v3 offset:41024
    ds_read_b64_tr_b16 v[102:103], v3 offset:43584
    buffer_load_dwordx4 v233, s[8:11], s55 offen offset:1024 lds
    v_mfma_f32_32x32x16_bf16 v[48:63], v[104:107], v[220:223], v[48:63]
    ds_read_b64_tr_b16 v[104:105], v3 offset:41088
    ds_read_b64_tr_b16 v[106:107], v3 offset:43648
    buffer_load_dwordx4 v234, s[8:11], s55 offen offset:2048 lds
    v_mfma_f32_32x32x16_bf16 v[64:79], v[108:111], v[220:223], v[64:79]
    ds_read_b64_tr_b16 v[108:109], v3 offset:41152
    ds_read_b64_tr_b16 v[110:111], v3 offset:43712
    buffer_load_dwordx4 v235, s[8:11], s55 offen offset:3072 lds
    v_mfma_f32_32x32x16_bf16 v[80:95], v[112:115], v[220:223], v[80:95]
    ds_read_b64_tr_b16 v[112:113], v3 offset:41216
    ds_read_b64_tr_b16 v[114:115], v3 offset:43776
    s_add_u32 m0, s57, 98304
    s_nop 0
    buffer_load_dwordx4 v236, s[8:11], s55 offen lds
    s_add_u32 s55, s55, s56
    buffer_load_dwordx4 v[220:223], v2, s[4:7], s59 offen sc1
    s_add_u32 s59, s59, 1024
    s_waitcnt vmcnt(13) lgkmcnt(0)
    v_mfma_f32_32x32x16_bf16 v[16:31], v[96:99], v[224:227], v[16:31]
    ds_read_b64_tr_b16 v[96:97], v3 offset:61440
    ds_read_b64_tr_b16 v[98:99], v3 offset:64000
    s_add_u32 m0, s57, 114688
    s_nop 0
    buffer_load_dwordx4 v232, s[8:11], s55 offen lds
    v_mfma_f32_32x32x16_bf16 v[32:47], v[100:103], v[224:227], v[32:47]
    ds_read_b64_tr_b16 v[100:101], v3 offset:61504
    ds_read_b64_tr_b16 v[102:103], v3 offset:64064
    buffer_load_dwordx4 v233, s[8:11], s55 offen offset:1024 lds
    v_mfma_f32_32x32x16_bf16 v[48:63], v[104:107], v[224:227], v[48:63]
    ds_read_b64_tr_b16 v[104:105], v3 offset:61568
    ds_read_b64_tr_b16 v[106:107], v3 offset:64128
    buffer_load_dwordx4 v234, s[8:11], s55 offen offset:2048 lds
    v_mfma_f32_32x32x16_bf16 v[64:79], v[108:111], v[224:227], v[64:79]
    ds_read_b64_tr_b16 v[108:109], v3 offset:61632
    ds_read_b64_tr_b16 v[110:111], v3 offset:64192
    buffer_load_dwordx4 v235, s[8:11], s55 offen offset:3072 lds
    v_mfma_f32_32x32x16_bf16 v[80:95], v[112:115], v[224:227], v[80:95]
    ds_read_b64_tr_b16 v[112:113], v3 offset:61696
    ds_read_b64_tr_b16 v[114:115], v3 offset:64256
    s_add_u32 m0, s57, 118784
    s_nop 0
    buffer_load_dwordx4 v236, s[8:11], s55 offen lds
    s_add_u32 s55, s55, s56
    buffer_load_dwordx4 v[224:227], v2, s[4:7], s59 offen sc1
    s_add_u32 s59, s59, 1024
    s_cmp_eq_u32 s58, 6
    s_cbranch_scc1 F_DONE
    s_cmp_lg_u32 s58, 5
    s_cbranch_scc1 F_NS
    s_mov_b32 s8, s40
    s_mov_b32 s9, s41
    s_mov_b32 s10, 819200
    s_mov_b32 s11, 0x00020000
    s_add_u32 s55, s95, 25600
    s_mov_b32 s56, 51200
    s_mov_b32 s59, 0x40000000
    buffer_load_dword v242, v243, s[4:7], 0 offen sc1
F_NS:
    s_waitcnt vmcnt(13) lgkmcnt(0)
    v_mfma_f32_32x32x16_bf16 v[16:31], v[96:99], v[228:231], v[16:31]
    ds_read_b64_tr_b16 v[96:97], v3 offset:0
    ds_read_b64_tr_b16 v[98:99], v3 offset:2560
    s_add_u32 m0, s57, 135168
    s_nop 0
    buffer_load_dwordx4 v232, s[8:11], s55 offen lds
    v_mfma_f32_32x32x16_bf16 v[32:47], v[100:103], v[228:231], v[32:47]
    ds_read_b64_tr_b16 v[100:101], v3 offset:64
    ds_read_b64_tr_b16 v[102:103], v3 offset:2624
    buffer_load_dwordx4 v233, s[8:11], s55 offen offset:1024 lds
    v_mfma_f32_32x32x16_bf16 v[48:63], v[104:107], v[228:231], v[48:63]
    ds_read_b64_tr_b16 v[104:105], v3 offset:128
    ds_read_b64_tr_b16 v[106:107], v3 offset:2688
    buffer_load_dwordx4 v234, s[8:11], s55 offen offset:2048 lds
    v_mfma_f32_32x32x16_bf16 v[64:79], v[108:111], v[228:231], v[64:79]
    ds_read_b64_tr_b16 v[108:109], v3 offset:192
    ds_read_b64_tr_b16 v[110:111], v3 offset:2752
    buffer_load_dwordx4 v235, s[8:11], s55 offen offset:3072 lds
    v_mfma_f32_32x32x16_bf16 v[80:95], v[112:115], v[228:231], v[80:95]
    ds_read_b64_tr_b16 v[112:113], v3 offset:256
    ds_read_b64_tr_b16 v[114:115], v3 offset:2816
    s_add_u32 m0, s57, 139264
    s_nop 0
    buffer_load_dwordx4 v236, s[8:11], s55 offen lds
    s_add_u32 s55, s55, s56
    buffer_load_dwordx4 v[228:231], v2, s[4:7], s59 offen sc1
    s_add_u32 s59, s59, 1024
    s_add_u32 s58, s58, 1
    s_sub_u32 s29, s58, 2
    s_cmp_ge_u32 s29, 3
    s_cbranch_scc1 F_LOOP
    s_cmp_eq_u32 s29, 1
    s_cbranch_scc1 F_X1
    s_cmp_eq_u32 s29, 2
    s_cbranch_scc1 F_X2
    s_lshl_b32 s30, s86, 2
    s_add_u32 s30, s30, s87
    s_mul_i32 s30, s30, 10240
    s_mul_i32 s29, s28, 3072
    s_min_u32 s29, s29, 7168
    s_add_u32 s29, s29, s30
    s_add_u32 s29, s29, 10035200
    s_cmp_eq_u32 s97, 0
    s_cbranch_scc1 SLOW_72
    buffer_store_dwordx4 v[248:251], v2, s[4:7], s29 offen offset:0
    buffer_store_dwordx4 v[248:251], v2, s[4:7], s29 offen offset:1024
    buffer_store_dwordx4 v[248:251], v2, s[4:7], s29 offen offset:2048
STD_73:
    s_add_u32 s30, s95, 0
    s_add_u32 m0, s57, 0
    s_nop 0
    buffer_load_dwordx4 v232, s[20:23], s30 offen lds
    buffer_load_dwordx4 v233, s[20:23], s30 offen offset:1024 lds
    buffer_load_dwordx4 v234, s[20:23], s30 offen offset:2048 lds
    buffer_load_dwordx4 v235, s[20:23], s30 offen offset:3072 lds
    s_add_u32 m0, s57, 4096
    s_nop 0
    buffer_load_dwordx4 v236, s[20:23], s30 offen lds
    s_add_u32 s30, s95, 51200
    s_add_u32 m0, s57, 20480
    s_nop 0
    buffer_load_dwordx4 v232, s[20:23], s30 offen lds
    buffer_load_dwordx4 v233, s[20:23], s30 offen offset:1024 lds
    buffer_load_dwordx4 v234, s[20:23], s30 offen offset:2048 lds
    buffer_load_dwordx4 v235, s[20:23], s30 offen offset:3072 lds
    s_add_u32 m0, s57, 24576
    s_nop 0
    buffer_load_dwordx4 v236, s[20:23], s30 offen lds
    s_add_u32 s30, s95, 102400
    s_add_u32 m0, s57, 40960
    s_nop 0
    buffer_load_dwordx4 v232, s[20:23], s30 offen lds
    buffer_load_dwordx4 v233, s[20:23], s30 offen offset:1024 lds
    buffer_load_dwordx4 v234, s[20:23], s30 offen offset:2048 lds
    buffer_load_dwordx4 v235, s[20:23], s30 offen offset:3072 lds
    s_add_u32 m0, s57, 45056
    s_nop 0
    buffer_load_dwordx4 v236, s[20:23], s30 offen lds
    s_branch F_LOOP
F_X1:
    ds_read_b64_tr_b16 v[116:117], v244 offset:0
    ds_read_b64_tr_b16 v[118:119], v244 offset:2560
    ds_read_b64_tr_b16 v[120:121], v244 offset:64
    ds_read_b64_tr_b16 v[122:123], v244 offset:2624
    ds_read_b64_tr_b16 v[124:125], v244 offset:128
    ds_read_b64_tr_b16 v[126:127], v244 offset:2688
    ds_read_b64_tr_b16 v[128:129], v244 offset:192
    ds_read_b64_tr_b16 v[130:131], v244 offset:2752
    ds_read_b64_tr_b16 v[132:133], v244 offset:256
    ds_read_b64_tr_b16 v[134:135], v244 offset:2816
    ds_read_b64_tr_b16 v[136:137], v244 offset:20480
    ds_read_b64_tr_b16 v[138:139], v244 offset:23040
    ds_read_b64_tr_b16 v[140:141], v244 offset:20544
    ds_read_b64_tr_b16 v[142:143], v244 offset:23104
    ds_read_b64_tr_b16 v[144:145], v244 offset:20608
    ds_read_b64_tr_b16 v[146:147], v244 offset:23168
    ds_read_b64_tr_b16 v[148:149], v244 offset:20672
    ds_read_b64_tr_b16 v[150:151], v244 offset:23232
    ds_read_b64_tr_b16 v[152:153], v244 offset:20736
    ds_read_b64_tr_b16 v[154:155], v244 offset:23296
    ds_read_b64_tr_b16 v[156:157], v244 offset:40960
    ds_read_b64_tr_b16 v[158:159], v244 offset:43520
    ds_read_b64_tr_b16 v[160:161], v244 offset:41024
    ds_read_b64_tr_b16 v[162:163], v244 offset:43584
    ds_read_b64_tr_b16 v[164:165], v244 offset:41088
    ds_read_b64_tr_b16 v[166:167], v244 offset:43648
    ds_read_b64_tr_b16 v[168:169], v244 offset:41152
    ds_read_b64_tr_b16 v[170:171], v244 offset:43712
    ds_read_b64_tr_b16 v[172:173], v244 offset:41216
    ds_read_b64_tr_b16 v[174:175], v244 offset:43776
    s_lshl_b32 s29, s28, 2
    s_add_u32 s29, s29, s94
    s_mov_b64 exec, 1
    s_cmp_eq_u32 s97, 0
    s_cbranch_scc1 SLOW_74
    buffer_store_dword v12, v7, s[4:7], s29 offen offset:16
STD_75:
    s_mov_b64 exec, -1
    s_waitcnt lgkmcnt(0)
    s_add_u32 s30, s95, 153600
    s_add_u32 m0, s57, 0
    s_nop 0
    buffer_load_dwordx4 v232, s[20:23], s30 offen lds
    buffer_load_dwordx4 v233, s[20:23], s30 offen offset:1024 lds
    buffer_load_dwordx4 v234, s[20:23], s30 offen offset:2048 lds
    buffer_load_dwordx4 v235, s[20:23], s30 offen offset:3072 lds
    s_add_u32 m0, s57, 4096
    s_nop 0
    buffer_load_dwordx4 v236, s[20:23], s30 offen lds
    s_add_u32 s30, s95, 122880
    s_add_u32 m0, s57, 20480
    s_nop 0
    buffer_load_dwordx4 v237, s[20:23], s30 offen lds
    buffer_load_dwordx4 v238, s[20:23], s30 offen offset:1024 lds
    buffer_load_dwordx4 v239, s[20:23], s30 offen offset:2048 lds
    buffer_load_dwordx4 v240, s[20:23], s30 offen offset:3072 lds
    s_add_u32 m0, s57, 24576
    s_nop 0
    buffer_load_dwordx4 v241, s[20:23], s30 offen lds
    s_branch F_LOOP
F_X2:
    ds_read_b64_tr_b16 v[176:177], v244 offset:0
    ds_read_b64_tr_b16 v[178:179], v244 offset:2560
    ds_read_b64_tr_b16 v[180:181], v244 offset:64
    ds_read_b64_tr_b16 v[182:183], v244 offset:2624
    ds_read_b64_tr_b16 v[184:185], v244 offset:128
    ds_read_b64_tr_b16 v[186:187], v244 offset:2688
    ds_read_b64_tr_b16 v[188:189], v244 offset:192
    ds_read_b64_tr_b16 v[190:191], v244 offset:2752
    ds_read_b64_tr_b16 v[192:193], v244 offset:256
    ds_read_b64_tr_b16 v[194:195], v244 offset:2816
    ds_read_b64_tr_b16 v[196:197], v244 offset:20480
    ds_read_b64_tr_b16 v[198:199], v244 offset:23040
    ds_read_b64_tr_b16 v[200:201], v244 offset:20544
    ds_read_b64_tr_b16 v[202:203], v244 offset:23104
    ds_read_b64_tr_b16 v[204:205], v244 offset:20608
    ds_read_b64_tr_b16 v[206:207], v244 offset:23168
    ds_read_b64_tr_b16 v[208:209], v244 offset:20672
    ds_read_b64_tr_b16 v[210:211], v244 offset:23232
    ds_read_b64_tr_b16 v[212:213], v244 offset:20736
    ds_read_b64_tr_b16 v[214:215], v244 offset:23296
    s_mov_b32 s99, 4194304
CW_76:
    ds_read_b32 v14, v13
    s_waitcnt lgkmcnt(0)
    v_readfirstlane_b32 s29, v14
    s_and_b32 s31, s29, 0xffff
    s_cmp_ge_u32 s31, 4
    s_cbranch_scc1 CWD_77
    s_sleep 1
    s_sub_u32 s99, s99, 1
    s_cbranch_scc0 CW_76
CWD_77:
    s_mov_b64 exec, 1
    ds_add_u32 v13, v245
    s_mov_b64 exec, -1
    s_branch F_LOOP
F_DONE:
    s_add_u32 s55, s95, 20480
    s_waitcnt lgkmcnt(0)
    s_add_u32 m0, s57, 135168
    s_nop 0
    buffer_load_dwordx4 v237, s[8:11], s55 offen lds
    buffer_load_dwordx4 v238, s[8:11], s55 offen offset:1024 lds
    buffer_load_dwordx4 v239, s[8:11], s55 offen offset:2048 lds
    buffer_load_dwordx4 v240, s[8:11], s55 offen offset:3072 lds
    s_add_u32 m0, s57, 139264
    s_nop 0
    buffer_load_dwordx4 v241, s[8:11], s55 offen lds
    buffer_load_dwordx4 v[8:11], v5, s[16:19], s93 offen
    v_cmp_ne_u32 vcc, s25, v242
    s_cbranch_vccz F_BOK
    s_mov_b32 s99, 262144
POLL_78:
    buffer_load_dword v15, v243, s[4:7], 0 offen sc1
    s_waitcnt vmcnt(0)
    v_cmp_ne_u32 vcc, s25, v15
    s_cbranch_vccz POLLED_79
    s_sleep 4
    s_sub_u32 s99, s99, 1
    s_cbranch_scc0 POLL_78
POLLED_79:
F_BOK:
    s_mul_i32 s59, s60, 10240
    s_add_u32 s59, s59, 10035200
    s_add_u32 s55, s59, 4096
    s_add_u32 s30, s59, 8192
    s_mov_b32 s99, 4194304
CW_80:
    ds_read_b32 v14, v13 offset:12
    s_waitcnt lgkmcnt(0)
    v_readfirstlane_b32 s29, v14
    s_and_b32 s31, s29, 0xffff
    s_cmp_ge_u32 s31, 8
    s_cbranch_scc1 CWD_81
    s_sleep 1
    s_sub_u32 s99, s99, 1
    s_cbranch_scc0 CW_80
CWD_81:
    s_mov_b32 s99, 262144
F_O:
    buffer_load_dwordx4 v[216:219], v2, s[4:7], s59 offen offset:0 sc1
    buffer_load_dwordx4 v[224:227], v2, s[4:7], s59 offen offset:2048 sc1
    buffer_load_dwordx4 v[232:235], v2, s[4:7], s55 offen offset:0 sc1
    buffer_load_dwordx4 v[240:243], v2, s[4:7], s55 offen offset:2048 sc1
    s_waitcnt vmcnt(3)
    v_max3_u32 v14, v216, v217, v218
    v_max_u32 v14, v14, v219
    s_waitcnt vmcnt(2)
    v_max3_u32 v14, v14, v224, v225
    v_max3_u32 v14, v14, v226, v227
    s_waitcnt vmcnt(1)
    v_max3_u32 v14, v14, v232, v233
    v_max3_u32 v14, v14, v234, v235
    s_waitcnt vmcnt(0)
    v_max3_u32 v14, v14, v240, v241
    v_max3_u32 v14, v14, v242, v243
    v_cmp_eq_u32 vcc, -1, v14
    s_cbranch_vccz F_OD
    s_sleep 1
    s_sub_u32 s99, s99, 1
    s_cbranch_scc0 F_O
F_OD:
    v_mfma_f32_32x32x16_bf16 v[16:31], v[116:119], v[216:219], v[16:31]
    ds_read_b64_tr_b16 v[116:117], v3 offset:0
    ds_read_b64_tr_b16 v[118:119], v3 offset:2560
    v_mfma_f32_32x32x16_bf16 v[32:47], v[120:123], v[216:219], v[32:47]
    ds_read_b64_tr_b16 v[120:121], v3 offset:64
    ds_read_b64_tr_b16 v[122:123], v3 offset:2624
    v_mfma_f32_32x32x16_bf16 v[48:63], v[124:127], v[216:219], v[48:63]
    ds_read_b64_tr_b16 v[124:125], v3 offset:128
    ds_read_b64_tr_b16 v[126:127], v3 offset:2688
    v_mfma_f32_32x32x16_bf16 v[64:79], v[128:131], v[216:219], v[64:79]
    ds_read_b64_tr_b16 v[128:129], v3 offset:192
    ds_read_b64_tr_b16 v[130:131], v3 offset:2752
    v_mfma_f32_32x32x16_bf16 v[80:95], v[132:135], v[216:219], v[80:95]
    ds_read_b64_tr_b16 v[132:133], v3 offset:256
    ds_read_b64_tr_b16 v[134:135], v3 offset:2816
    buffer_load_dwordx4 v[220:223], v2, s[4:7], s59 offen offset:1024 sc1
    buffer_load_dwordx4 v[252:255], v2, s[4:7], s30 offen offset:1024 sc1
    buffer_load_dwordx4 v[228:231], v2, s[4:7], s59 offen offset:3072 sc1
    buffer_load_dwordx4 v[236:239], v2, s[4:7], s55 offen offset:1024 sc1
    buffer_load_dwordx4 v[244:247], v2, s[4:7], s55 offen offset:3072 sc1
    buffer_load_dwordx4 v[248:251], v2, s[4:7], s30 offen offset:0 sc1
    v_mfma_f32_32x32x16_bf16 v[16:31], v[136:139], v[224:227], v[16:31]
    ds_read_b64_tr_b16 v[136:137], v3 offset:20480
    ds_read_b64_tr_b16 v[138:139], v3 offset:23040
    v_mfma_f32_32x32x16_bf16 v[32:47], v[140:143], v[224:227], v[32:47]
    ds_read_b64_tr_b16 v[140:141], v3 offset:20544
    ds_read_b64_tr_b16 v[142:143], v3 offset:23104
    v_mfma_f32_32x32x16_bf16 v[48:63], v[144:147], v[224:227], v[48:63]
    ds_read_b64_tr_b16 v[144:145], v3 offset:20608
    ds_read_b64_tr_b16 v[146:147], v3 offset:23168
    v_mfma_f32_32x32x16_bf16 v[64:79], v[148:151], v[224:227], v[64:79]
    ds_read_b64_tr_b16 v[148:149], v3 offset:20672
    ds_read_b64_tr_b16 v[150:151], v3 offset:23232
    v_mfma_f32_32x32x16_bf16 v[80:95], v[152:155], v[224:227], v[80:95]
    ds_read_b64_tr_b16 v[152:153], v3 offset:20736
    ds_read_b64_tr_b16 v[154:155], v3 offset:23296
    v_mfma_f32_32x32x16_bf16 v[16:31], v[156:159], v[232:235], v[16:31]
    ds_read_b64_tr_b16 v[156:157], v3 offset:40960
    ds_read_b64_tr_b16 v[158:159], v3 offset:43520
    v_mfma_f32_32x32x16_bf16 v[32:47], v[160:163], v[232:235], v[32:47]
    ds_read_b64_tr_b16 v[160:161], v3 offset:41024
    ds_read_b64_tr_b16 v[162:163], v3 offset:43584
    v_mfma_f32_32x32x16_bf16 v[48:63], v[164:167], v[232:235], v[48:63]
    ds_read_b64_tr_b16 v[164:165], v3 offset:41088
    ds_read_b64_tr_b16 v[166:167], v3 offset:43648
    v_mfma_f32_32x32x16_bf16 v[64:79], v[168:171], v[232:235], v[64:79]
    ds_read_b64_tr_b16 v[168:169], v3 offset:41152
    ds_read_b64_tr_b16 v[170:171], v3 offset:43712
    v_mfma_f32_32x32x16_bf16 v[80:95], v[172:175], v[232:235], v[80:95]
    ds_read_b64_tr_b16 v[172:173], v3 offset:41216
    ds_read_b64_tr_b16 v[174:175], v3 offset:43776
    v_mfma_f32_32x32x16_bf16 v[16:31], v[176:179], v[240:243], v[16:31]
    ds_read_b64_tr_b16 v[176:177], v3 offset:61440
    ds_read_b64_tr_b16 v[178:179], v3 offset:64000
    v_mfma_f32_32x32x16_bf16 v[32:47], v[180:183], v[240:243], v[32:47]
    ds_read_b64_tr_b16 v[180:181], v3 offset:61504
    ds_read_b64_tr_b16 v[182:183], v3 offset:64064
    v_mfma_f32_32x32x16_bf16 v[48:63], v[184:187], v[240:243], v[48:63]
    ds_read_b64_tr_b16 v[184:185], v3 offset:61568
    ds_read_b64_tr_b16 v[186:187], v3 offset:64128
    v_mfma_f32_32x32x16_bf16 v[64:79], v[188:191], v[240:243], v[64:79]
    ds_read_b64_tr_b16 v[188:189], v3 offset:61632
    ds_read_b64_tr_b16 v[190:191], v3 offset:64192
    v_mfma_f32_32x32x16_bf16 v[80:95], v[192:195], v[240:243], v[80:95]
    ds_read_b64_tr_b16 v[192:193], v3 offset:61696
    ds_read_b64_tr_b16 v[194:195], v3 offset:64256
    s_mov_b32 s99, 4194304
CW_82:
    ds_read_b32 v14, v13
    s_waitcnt lgkmcnt(0)
    v_readfirstlane_b32 s29, v14
    s_and_b32 s31, s29, 0xffff
    s_cmp_ge_u32 s31, 16
    s_cbranch_scc1 CWD_83
    s_sleep 1
    s_sub_u32 s99, s99, 1
    s_cbranch_scc0 CW_82
CWD_83:
    s_cmp_lt_u32 s29, 0x10000
    s_cbranch_scc1 F_NORE
    s_mov_b32 s99, 4194304
CW_84:
    ds_read_b32 v14, v13
    s_waitcnt lgkmcnt(0)
    v_readfirstlane_b32 s29, v14
    s_and_b32 s31, s29, 0xffff
    s_cmp_ge_u32 s31, 32
    s_cbranch_scc1 CWD_85
    s_sleep 8
    s_sub_u32 s99, s99, 1
    s_cbranch_scc0 CW_84
CWD_85:
F_NORE:
    s_mov_b32 s99, 262144
F_O2:
    s_waitcnt vmcnt(5)
    v_max3_u32 v14, v220, v221, v222
    v_max_u32 v14, v14, v223
    s_waitcnt vmcnt(4)
    v_max3_u32 v14, v14, v252, v253
    v_max3_u32 v14, v14, v254, v255
    s_waitcnt vmcnt(3)
    v_max3_u32 v14, v14, v228, v229
    v_max3_u32 v14, v14, v230, v231
    s_waitcnt vmcnt(2)
    v_max3_u32 v14, v14, v236, v237
    v_max3_u32 v14, v14, v238, v239
    s_waitcnt vmcnt(1)
    v_max3_u32 v14, v14, v244, v245
    v_max3_u32 v14, v14, v246, v247
    s_waitcnt vmcnt(0)
    v_max3_u32 v14, v14, v248, v249
    v_max3_u32 v14, v14, v250, v251
    v_cmp_eq_u32 vcc, -1, v14
    s_cbranch_vccz F_OD2
    buffer_load_dwordx4 v[220:223], v2, s[4:7], s59 offen offset:1024 sc1
    buffer_load_dwordx4 v[252:255], v2, s[4:7], s30 offen offset:1024 sc1
    buffer_load_dwordx4 v[228:231], v2, s[4:7], s59 offen offset:3072 sc1
    buffer_load_dwordx4 v[236:239], v2, s[4:7], s55 offen offset:1024 sc1
    buffer_load_dwordx4 v[244:247], v2, s[4:7], s55 offen offset:3072 sc1
    buffer_load_dwordx4 v[248:251], v2, s[4:7], s30 offen offset:0 sc1
    s_sub_u32 s99, s99, 1
    s_cbranch_scc0 F_O2
    s_waitcnt vmcnt(0)
F_OD2:
    v_mfma_f32_32x32x16_bf16 v[16:31], v[96:99], v[220:223], v[16:31]
    v_mfma_f32_32x32x16_bf16 v[16:31], v[196:199], v[252:255], v[16:31]
    v_mfma_f32_32x32x16_bf16 v[16:31], v[116:119], v[228:231], v[16:31]
    v_mfma_f32_32x32x16_bf16 v[16:31], v[136:139], v[236:239], v[16:31]
    v_mfma_f32_32x32x16_bf16 v[16:31], v[156:159], v[244:247], v[16:31]
    v_mfma_f32_32x32x16_bf16 v[16:31], v[176:179], v[248:251], v[16:31]
    v_mfma_f32_32x32x16_bf16 v[32:47], v[100:103], v[220:223], v[32:47]
    s_nop 4
    v_mfma_f32_32x32x16_bf16 v[32:47], v[200:203], v[252:255], v[32:47]
    s_nop 4
    v_mfma_f32_32x32x16_bf16 v[32:47], v[120:123], v[228:231], v[32:47]
    ds_write_b128 v0, v[16:19] offset:0
    v_mfma_f32_32x32x16_bf16 v[32:47], v[140:143], v[236:239], v[32:47]
    ds_write_b128 v0, v[20:23] offset:32
    v_mfma_f32_32x32x16_bf16 v[32:47], v[160:163], v[244:247], v[32:47]
    ds_write_b128 v0, v[24:27] offset:64
    v_mfma_f32_32x32x16_bf16 v[32:47], v[180:183], v[248:251], v[32:47]
    ds_write_b128 v0, v[28:31] offset:96
    v_mfma_f32_32x32x16_bf16 v[48:63], v[104:107], v[220:223], v[48:63]
    s_nop 4
    v_mfma_f32_32x32x16_bf16 v[48:63], v[204:207], v[252:255], v[48:63]
    s_nop 4
    v_mfma_f32_32x32x16_bf16 v[48:63], v[124:127], v[228:231], v[48:63]
    ds_write_b128 v0, v[32:35] offset:20480
    v_mfma_f32_32x32x16_bf16 v[48:63], v[144:147], v[236:239], v[48:63]
    ds_write_b128 v0, v[36:39] offset:20512
    v_mfma_f32_32x32x16_bf16 v[48:63], v[164:167], v[244:247], v[48:63]
    ds_write_b128 v0, v[40:43] offset:20544
    v_mfma_f32_32x32x16_bf16 v[48:63], v[184:187], v[248:251], v[48:63]
    ds_write_b128 v0, v[44:47] offset:20576
    v_mfma_f32_32x32x16_bf16 v[64:79], v[108:111], v[220:223], v[64:79]
    s_nop 4
    v_mfma_f32_32x32x16_bf16 v[64:79], v[208:211], v[252:255], v[64:79]
    s_waitcnt lgkmcnt(0)
    s_barrier
    s_nop 2
    v_mfma_f32_32x32x16_bf16 v[64:79], v[128:131], v[228:231], v[64:79]
    ds_write_b128 v6, v[48:51] offset:0
    v_mfma_f32_32x32x16_bf16 v[64:79], v[148:151], v[236:239], v[64:79]
    ds_write_b128 v6, v[52:55] offset:32
    v_mfma_f32_32x32x16_bf16 v[64:79], v[168:171], v[244:247], v[64:79]
    ds_write_b128 v6, v[56:59] offset:64
    v_mfma_f32_32x32x16_bf16 v[64:79], v[188:191], v[248:251], v[64:79]
    ds_write_b128 v6, v[60:63] offset:96
    v_mfma_f32_32x32x16_bf16 v[80:95], v[112:115], v[220:223], v[80:95]
    s_nop 4
    v_mfma_f32_32x32x16_bf16 v[80:95], v[212:215], v[252:255], v[80:95]
    s_nop 4
    v_mfma_f32_32x32x16_bf16 v[80:95], v[132:135], v[228:231], v[80:95]
    ds_write_b128 v6, v[64:67] offset:20480
    v_mfma_f32_32x32x16_bf16 v[80:95], v[152:155], v[236:239], v[80:95]
    ds_write_b128 v6, v[68:71] offset:20512
    v_mfma_f32_32x32x16_bf16 v[80:95], v[172:175], v[244:247], v[80:95]
    ds_write_b128 v6, v[72:75] offset:20544
    v_mfma_f32_32x32x16_bf16 v[80:95], v[192:195], v[248:251], v[80:95]
    ds_write_b128 v6, v[76:79] offset:20576
    v_lshlrev_b32 v208, 16, v8
    v_and_b32 v209, 0xffff0000, v8
    v_lshlrev_b32 v210, 16, v9
    v_and_b32 v211, 0xffff0000, v9
    v_lshlrev_b32 v212, 16, v10
    v_and_b32 v213, 0xffff0000, v10
    v_lshlrev_b32 v214, 16, v11
    v_and_b32 v215, 0xffff0000, v11
    s_nop 3
    ds_write_b128 v6, v[80:83] offset:40960
    ds_write_b128 v6, v[84:87] offset:40992
    ds_write_b128 v6, v[88:91] offset:41024
    ds_write_b128 v6, v[92:95] offset:41056
    s_waitcnt lgkmcnt(0)
    s_barrier
    ds_read_b128 v[176:179], v4 offset:0
    ds_read_b128 v[180:183], v4 offset:16
    ds_read_b128 v[184:187], v4 offset:5120
    ds_read_b128 v[188:191], v4 offset:5136
    ds_read_b128 v[192:195], v4 offset:10240
    ds_read_b128 v[196:199], v4 offset:10256
    ds_read_b128 v[200:203], v4 offset:15360
    ds_read_b128 v[204:207], v4 offset:15376
    s_waitcnt lgkmcnt(6)
    v_pk_add_f32 v[208:209], v[208:209], v[176:177]
    v_pk_add_f32 v[210:211], v[210:211], v[178:179]
    v_pk_add_f32 v[212:213], v[212:213], v[180:181]
    v_pk_add_f32 v[214:215], v[214:215], v[182:183]
    s_waitcnt lgkmcnt(4)
    v_pk_add_f32 v[208:209], v[208:209], v[184:185]
    v_pk_add_f32 v[210:211], v[210:211], v[186:187]
    v_pk_add_f32 v[212:213], v[212:213], v[188:189]
    v_pk_add_f32 v[214:215], v[214:215], v[190:191]
    s_waitcnt lgkmcnt(2)
    v_pk_add_f32 v[208:209], v[208:209], v[192:193]
    v_pk_add_f32 v[210:211], v[210:211], v[194:195]
    v_pk_add_f32 v[212:213], v[212:213], v[196:197]
    v_pk_add_f32 v[214:215], v[214:215], v[198:199]
    s_waitcnt lgkmcnt(0)
    v_pk_add_f32 v[208:209], v[208:209], v[200:201]
    v_pk_add_f32 v[210:211], v[210:211], v[202:203]
    v_pk_add_f32 v[212:213], v[212:213], v[204:205]
    v_pk_add_f32 v[214:215], v[214:215], v[206:207]
    v_cvt_pk_bf16_f32 v8, v208, v209
    v_cvt_pk_bf16_f32 v9, v210, v211
    v_cvt_pk_bf16_f32 v10, v212, v213
    v_cvt_pk_bf16_f32 v11, v214, v215
    buffer_store_dwordx4 v[8:11], v5, s[12:15], s93 offen
    s_endpgm
SLOW_5:
    buffer_store_dwordx4 v[160:163], v6, s[4:7], s29 offen offset:0 sc1
    buffer_store_dwordx4 v[164:167], v6, s[4:7], s29 offen offset:1024 sc1
    s_branch STD_6
SLOW_8:
    buffer_store_dwordx4 v[168:171], v6, s[4:7], s29 offen offset:0 sc1
    buffer_store_dwordx4 v[172:175], v6, s[4:7], s29 offen offset:1024 sc1
    s_branch STD_9
SLOW_11:
    buffer_store_dwordx4 v[176:179], v6, s[4:7], s29 offen offset:0 sc1
    buffer_store_dwordx4 v[180:183], v6, s[4:7], s29 offen offset:1024 sc1
    s_branch STD_12
SLOW_14:
    buffer_store_dwordx4 v[184:187], v6, s[4:7], s29 offen offset:0 sc1
    buffer_store_dwordx4 v[188:191], v6, s[4:7], s29 offen offset:1024 sc1
    s_branch STD_15
SLOW_16:
    buffer_store_dword v32, v7, s[4:7], s29 offen offset:32 sc1
    s_branch STD_17
SLOW_28:
    buffer_store_dwordx4 v[212:215], v6, s[4:7], s29 offen offset:0 sc1
    buffer_store_dwordx4 v[216:219], v6, s[4:7], s29 offen offset:1024 sc1
    s_branch STD_29
SLOW_31:
    buffer_store_dword v21, v7, s[4:7], s29 offen offset:32 sc1
    s_branch STD_32
SLOW_51:
    buffer_store_dwordx4 v[128:131], v2, s[4:7], s48 offen offset:0 sc1
    buffer_store_dwordx2 v[132:133], v3, s[4:7], s49 offen offset:0 sc1
    s_branch STD_52
SLOW_56:
    buffer_store_dwordx4 v[136:139], v2, s[4:7], s48 offen offset:1024 sc1
    buffer_store_dwordx2 v[140:141], v3, s[4:7], s49 offen offset:512 sc1
    s_branch STD_57
SLOW_72:
    buffer_store_dwordx4 v[248:251], v2, s[4:7], s29 offen offset:0 sc1
    buffer_store_dwordx4 v[248:251], v2, s[4:7], s29 offen offset:1024 sc1
    buffer_store_dwordx4 v[248:251], v2, s[4:7], s29 offen offset:2048 sc1
    s_branch STD_73
SLOW_74:
    buffer_store_dword v12, v7, s[4:7], s29 offen offset:16 sc1
    s_branch STD_75
L_END:
    s_endpgm
    .fill (0x8100 - (. - parallel_sum__grouped_kv_mqa__dense_activation_relu__prompt_kernel)) / 4, 4, 0xbf810000
.section .rodata,"a"
.p2align 6
.amdhsa_kernel parallel_sum__grouped_kv_mqa__dense_activation_relu__prompt_kernel
  .amdhsa_next_free_vgpr 256
  .amdhsa_next_free_sgpr 102
  .amdhsa_accum_offset 256
  .amdhsa_group_segment_fixed_size 0
  .amdhsa_kernarg_size 88
  .amdhsa_user_sgpr_count 2
  .amdhsa_user_sgpr_kernarg_segment_ptr 1
  .amdhsa_system_sgpr_workgroup_id_x 1
.end_amdhsa_kernel
```
